```python
import torch

def _softmax(x, axis=-1):
    return torch.softmax(x, dim=axis)
def _gelu(x):
    return torch.nn.functional.gelu(x, approximate="tanh")
def _silu(x):
    return torch.nn.functional.silu(x)
def _sigmoid(x):
    return torch.sigmoid(x)
def _layernorm(x, axis=-1, eps=1e-5):
    m = x.mean(dim=axis, keepdim=True)
    v = x.var(dim=axis, keepdim=True, unbiased=False)
    return (x - m) / torch.sqrt(v + eps)
def _scatter_add(tgt, idx, src, axis=0):
    return tgt.clone().index_add_(axis, idx, src)
def _segment_sum(src, seg, n):
    out = torch.zeros((n,) + src.shape[1:], dtype=src.dtype)
    return out.index_add_(0, seg, src)
def _pad(x, pw):
    flat = tuple(v for pair in reversed(pw) for v in pair)
    return torch.nn.functional.pad(x, flat)

kernel_name = 'standalone__ssm_conv_s5__prompt'

def setup_inputs():

    _w = (lambda a: (lambda t: t.to(torch.bfloat16) if t.is_floating_point() else t)(torch.as_tensor(a)))
    B, S, D = 1, 2048, 1024
    P = D
    Lambda_re = -0.5 * (lambda _x: torch.exp(torch.as_tensor(_x)))((lambda *s: torch.randn(*s, dtype=torch.bfloat16) * 0.2)(P))
    Lambda_im = (lambda *s: torch.randn(*s, dtype=torch.bfloat16) * 0.4)(P) * 1.0
    B_re = (lambda *s: torch.randn(*s, dtype=torch.bfloat16) * 0.2)(P, D) * (D ** -0.5)
    B_im = (lambda *s: torch.randn(*s, dtype=torch.bfloat16) * 0.2)(P, D) * (D ** -0.5)
    C_re = (lambda *s: torch.randn(*s, dtype=torch.bfloat16) * 0.2)(D, P) * (P ** -0.5)
    C_im = (lambda *s: torch.randn(*s, dtype=torch.bfloat16) * 0.2)(D, P) * (P ** -0.5)
    log_dt = (lambda *s: torch.randn(*s, dtype=torch.bfloat16) * 0.2)(P) * 0.3 - 2.0
    Dskip = (lambda *s: torch.randn(*s, dtype=torch.bfloat16) * 0.05)(D)
    return {
        "x": _w((lambda *s: torch.randn(*s, dtype=torch.bfloat16) * 0.05)(B, S, D)),
        "Lambda_re": _w(Lambda_re),
        "Lambda_im": _w(Lambda_im),
        "B_re": _w(B_re),
        "B_im": _w(B_im),
        "C_re": _w(C_re),
        "C_im": _w(C_im),
        "log_dt": _w(log_dt),
        "Dskip": _w(Dskip),
    }

def reference(x, Lambda_re, Lambda_im, B_re, B_im, C_re, C_im, log_dt, Dskip):
    Bsz, L, H = x.shape
    Lam = Lambda_re + 1j * Lambda_im
    Bmat = B_re + 1j * B_im
    Cmat = C_re + 1j * C_im
    dt = torch.exp(log_dt)
    Lam_bar = torch.exp(dt * Lam)
    B_bar = ((Lam_bar - 1.0) / Lam)[:, None] * Bmat
    Bu = torch.einsum("bld,pd->blp", x + 0j, B_bar)
    h = torch.zeros_like(Bu[:, 0, :])
    hs = []
    for t in range(L):
        h = Lam_bar[None, :] * h + Bu[:, t, :]
        hs.append(h)
    hseq = torch.stack(hs, 1)
    y = 2.0 * torch.einsum("blp,dp->bld", hseq, Cmat).real + x * Dskip[None, None, :]
    return y
```

```asm
; @launch kernel=ssm_k1_kernel grid=(256,1,1) block=(512,1,1) lds=133120
; @launch kernel=ssm_k2_kernel grid=(256,1,1) block=(512,1,1) lds=147456
.amdgcn_target "amdgcn-amd-amdhsa--gfx950"
.text
.globl ssm_k1_kernel
.p2align 8
.type ssm_k1_kernel,@function
ssm_k1_kernel:
    s_cmp_ge_u32 s2, 256
    s_cbranch_scc1 K1_END
    s_load_dwordx2 s[4:5], s[0:1], 0
    s_load_dwordx2 s[8:9], s[0:1], 24
    s_load_dwordx2 s[12:13], s[0:1], 32
    s_load_dwordx2 s[16:17], s[0:1], 88
    s_load_dwordx2 s[18:19], s[0:1], 80
    s_load_dwordx2 s[20:21], s[0:1], 8
    s_load_dwordx2 s[22:23], s[0:1], 16
    s_load_dwordx2 s[24:25], s[0:1], 56
    s_load_dwordx2 s[40:41], s[0:1], 40
    s_load_dwordx2 s[42:43], s[0:1], 48

    s_and_b32 s26, s2, 7
    s_lshr_b32 s27, s2, 3
    s_and_b32 s30, s26, 3
    s_lshl_b32 s30, s30, 2
    s_and_b32 s31, s27, 3
    s_add_u32 s30, s30, s31
    s_lshr_b32 s31, s26, 2
    s_lshl_b32 s31, s31, 3
    s_lshr_b32 s27, s27, 2
    s_add_u32 s31, s31, s27
    v_lshrrev_b32 v1, 6, v0
    v_and_b32 v0, 63, v0
    v_readfirstlane_b32 s28, v1
    s_nop 3
    s_cmp_lt_u32 s28, 4
    s_cbranch_scc1 K1_MAIN
    s_setprio 0
    s_sub_u32 s28, s28, 4
    v_lshrrev_b32 v1, 3, v0
    v_lshlrev_b32 v1, 11, v1
    v_lshrrev_b32 v2, 4, v0
    v_xor_b32 v2, v2, v0
    v_and_b32 v2, 7, v2
    v_lshlrev_b32 v2, 4, v2
    v_add_u32 v1, v1, v2
    v_xor_b32 v2, 64, v1
    v_add_u32 v2, 0x4000, v2
    v_add_u32 v3, 0x8000, v1
    v_add_u32 v4, 0x8000, v2
    s_lshl_b32 s32, s30, 18
    s_lshl_b32 s33, s28, 16
    s_add_u32 s32, s32, s33
    s_lshl_b32 s33, s31, 17
    s_lshl_b32 s34, s28, 15
    s_add_u32 s33, s33, s34
    s_lshl_b32 s34, s28, 12
    s_lshl_b32 s38, s28, 11
    s_mov_b32 s44, s32
    s_mov_b32 s45, s33
    s_lshr_b32 s46, s2, 3
    s_and_b32 s46, s46, 15
    s_lshl_b32 s46, s46, 7
    s_waitcnt lgkmcnt(0)

    s_and_b32 s5, s5, 0xffff
    s_mov_b32 s6, 4194304
    s_mov_b32 s7, 0x00020000
    s_and_b32 s9, s9, 0xffff
    s_mov_b32 s10, 2097152
    s_mov_b32 s11, 0x00020000
    s_and_b32 s13, s13, 0xffff
    s_mov_b32 s14, 2097152
    s_mov_b32 s15, 0x00020000
    s_add_u32 s32, s44, s46
    s_add_u32 s33, s45, s46
    s_add_u32 m0, s34, 0
    s_nop 0
    buffer_load_dwordx4 v1, s[4:7], s32 offen lds
    s_add_u32 m0, s34, 1024
    s_nop 0
    buffer_load_dwordx4 v2, s[4:7], s32 offen lds
    s_add_u32 m0, s34, 2048
    s_nop 0
    buffer_load_dwordx4 v3, s[4:7], s32 offen lds
    s_add_u32 m0, s34, 3072
    s_nop 0
    buffer_load_dwordx4 v4, s[4:7], s32 offen lds
    s_add_u32 m0, s38, 16384
    s_nop 0
    buffer_load_dwordx4 v1, s[8:11], s33 offen lds
    s_add_u32 m0, s38, 17408
    s_nop 0
    buffer_load_dwordx4 v2, s[8:11], s33 offen lds
    s_add_u32 m0, s38, 24576
    s_nop 0
    buffer_load_dwordx4 v1, s[12:15], s33 offen lds
    s_add_u32 m0, s38, 25600
    s_nop 0
    buffer_load_dwordx4 v2, s[12:15], s33 offen lds
    s_add_u32 s46, s46, 128
    s_and_b32 s46, s46, 2047
    s_add_u32 s32, s44, s46
    s_add_u32 s33, s45, s46
    s_add_u32 m0, s34, 32768
    s_nop 0
    buffer_load_dwordx4 v1, s[4:7], s32 offen lds
    s_add_u32 m0, s34, 33792
    s_nop 0
    buffer_load_dwordx4 v2, s[4:7], s32 offen lds
    s_add_u32 m0, s34, 34816
    s_nop 0
    buffer_load_dwordx4 v3, s[4:7], s32 offen lds
    s_add_u32 m0, s34, 35840
    s_nop 0
    buffer_load_dwordx4 v4, s[4:7], s32 offen lds
    s_add_u32 m0, s38, 49152
    s_nop 0
    buffer_load_dwordx4 v1, s[8:11], s33 offen lds
    s_add_u32 m0, s38, 50176
    s_nop 0
    buffer_load_dwordx4 v2, s[8:11], s33 offen lds
    s_add_u32 m0, s38, 57344
    s_nop 0
    buffer_load_dwordx4 v1, s[12:15], s33 offen lds
    s_add_u32 m0, s38, 58368
    s_nop 0
    buffer_load_dwordx4 v2, s[12:15], s33 offen lds
    s_add_u32 s46, s46, 128
    s_and_b32 s46, s46, 2047
    s_add_u32 s32, s44, s46
    s_add_u32 s33, s45, s46
    s_add_u32 m0, s34, 65536
    s_nop 0
    buffer_load_dwordx4 v1, s[4:7], s32 offen lds
    s_add_u32 m0, s34, 66560
    s_nop 0
    buffer_load_dwordx4 v2, s[4:7], s32 offen lds
    s_add_u32 m0, s34, 67584
    s_nop 0
    buffer_load_dwordx4 v3, s[4:7], s32 offen lds
    s_add_u32 m0, s34, 68608
    s_nop 0
    buffer_load_dwordx4 v4, s[4:7], s32 offen lds
    s_add_u32 m0, s38, 81920
    s_nop 0
    buffer_load_dwordx4 v1, s[8:11], s33 offen lds
    s_add_u32 m0, s38, 82944
    s_nop 0
    buffer_load_dwordx4 v2, s[8:11], s33 offen lds
    s_add_u32 m0, s38, 90112
    s_nop 0
    buffer_load_dwordx4 v1, s[12:15], s33 offen lds
    s_add_u32 m0, s38, 91136
    s_nop 0
    buffer_load_dwordx4 v2, s[12:15], s33 offen lds
    s_add_u32 s46, s46, 128
    s_and_b32 s46, s46, 2047
    s_mov_b32 s35, 3
K1_PLOOP:
    s_waitcnt vmcnt(16)
    s_barrier
    s_add_u32 s32, s44, s46
    s_add_u32 s33, s45, s46
    s_add_u32 m0, s34, 98304
    s_nop 0
    buffer_load_dwordx4 v1, s[4:7], s32 offen lds
    s_add_u32 m0, s34, 99328
    s_nop 0
    buffer_load_dwordx4 v2, s[4:7], s32 offen lds
    s_add_u32 m0, s34, 100352
    s_nop 0
    buffer_load_dwordx4 v3, s[4:7], s32 offen lds
    s_add_u32 m0, s34, 101376
    s_nop 0
    buffer_load_dwordx4 v4, s[4:7], s32 offen lds
    s_add_u32 m0, s38, 114688
    s_nop 0
    buffer_load_dwordx4 v1, s[8:11], s33 offen lds
    s_add_u32 m0, s38, 115712
    s_nop 0
    buffer_load_dwordx4 v2, s[8:11], s33 offen lds
    s_add_u32 m0, s38, 122880
    s_nop 0
    buffer_load_dwordx4 v1, s[12:15], s33 offen lds
    s_add_u32 m0, s38, 123904
    s_nop 0
    buffer_load_dwordx4 v2, s[12:15], s33 offen lds
    s_add_u32 s46, s46, 128
    s_and_b32 s46, s46, 2047
    s_waitcnt vmcnt(16)
    s_barrier
    s_add_u32 s32, s44, s46
    s_add_u32 s33, s45, s46
    s_add_u32 m0, s34, 0
    s_nop 0
    buffer_load_dwordx4 v1, s[4:7], s32 offen lds
    s_add_u32 m0, s34, 1024
    s_nop 0
    buffer_load_dwordx4 v2, s[4:7], s32 offen lds
    s_add_u32 m0, s34, 2048
    s_nop 0
    buffer_load_dwordx4 v3, s[4:7], s32 offen lds
    s_add_u32 m0, s34, 3072
    s_nop 0
    buffer_load_dwordx4 v4, s[4:7], s32 offen lds
    s_add_u32 m0, s38, 16384
    s_nop 0
    buffer_load_dwordx4 v1, s[8:11], s33 offen lds
    s_add_u32 m0, s38, 17408
    s_nop 0
    buffer_load_dwordx4 v2, s[8:11], s33 offen lds
    s_add_u32 m0, s38, 24576
    s_nop 0
    buffer_load_dwordx4 v1, s[12:15], s33 offen lds
    s_add_u32 m0, s38, 25600
    s_nop 0
    buffer_load_dwordx4 v2, s[12:15], s33 offen lds
    s_add_u32 s46, s46, 128
    s_and_b32 s46, s46, 2047
    s_waitcnt vmcnt(16)
    s_barrier
    s_add_u32 s32, s44, s46
    s_add_u32 s33, s45, s46
    s_add_u32 m0, s34, 32768
    s_nop 0
    buffer_load_dwordx4 v1, s[4:7], s32 offen lds
    s_add_u32 m0, s34, 33792
    s_nop 0
    buffer_load_dwordx4 v2, s[4:7], s32 offen lds
    s_add_u32 m0, s34, 34816
    s_nop 0
    buffer_load_dwordx4 v3, s[4:7], s32 offen lds
    s_add_u32 m0, s34, 35840
    s_nop 0
    buffer_load_dwordx4 v4, s[4:7], s32 offen lds
    s_add_u32 m0, s38, 49152
    s_nop 0
    buffer_load_dwordx4 v1, s[8:11], s33 offen lds
    s_add_u32 m0, s38, 50176
    s_nop 0
    buffer_load_dwordx4 v2, s[8:11], s33 offen lds
    s_add_u32 m0, s38, 57344
    s_nop 0
    buffer_load_dwordx4 v1, s[12:15], s33 offen lds
    s_add_u32 m0, s38, 58368
    s_nop 0
    buffer_load_dwordx4 v2, s[12:15], s33 offen lds
    s_add_u32 s46, s46, 128
    s_and_b32 s46, s46, 2047
    s_waitcnt vmcnt(16)
    s_barrier
    s_add_u32 s32, s44, s46
    s_add_u32 s33, s45, s46
    s_add_u32 m0, s34, 65536
    s_nop 0
    buffer_load_dwordx4 v1, s[4:7], s32 offen lds
    s_add_u32 m0, s34, 66560
    s_nop 0
    buffer_load_dwordx4 v2, s[4:7], s32 offen lds
    s_add_u32 m0, s34, 67584
    s_nop 0
    buffer_load_dwordx4 v3, s[4:7], s32 offen lds
    s_add_u32 m0, s34, 68608
    s_nop 0
    buffer_load_dwordx4 v4, s[4:7], s32 offen lds
    s_add_u32 m0, s38, 81920
    s_nop 0
    buffer_load_dwordx4 v1, s[8:11], s33 offen lds
    s_add_u32 m0, s38, 82944
    s_nop 0
    buffer_load_dwordx4 v2, s[8:11], s33 offen lds
    s_add_u32 m0, s38, 90112
    s_nop 0
    buffer_load_dwordx4 v1, s[12:15], s33 offen lds
    s_add_u32 m0, s38, 91136
    s_nop 0
    buffer_load_dwordx4 v2, s[12:15], s33 offen lds
    s_add_u32 s46, s46, 128
    s_and_b32 s46, s46, 2047
    s_sub_u32 s35, s35, 1
    s_cmp_lg_u32 s35, 0
    s_cbranch_scc1 K1_PLOOP
    s_waitcnt vmcnt(16)
    s_barrier

    s_add_u32 s32, s44, s46
    s_add_u32 s33, s45, s46
    s_add_u32 m0, s34, 98304
    s_nop 0
    buffer_load_dwordx4 v1, s[4:7], s32 offen lds
    s_add_u32 m0, s34, 99328
    s_nop 0
    buffer_load_dwordx4 v2, s[4:7], s32 offen lds
    s_add_u32 m0, s34, 100352
    s_nop 0
    buffer_load_dwordx4 v3, s[4:7], s32 offen lds
    s_add_u32 m0, s34, 101376
    s_nop 0
    buffer_load_dwordx4 v4, s[4:7], s32 offen lds
    s_add_u32 m0, s38, 114688
    s_nop 0
    buffer_load_dwordx4 v1, s[8:11], s33 offen lds
    s_add_u32 m0, s38, 115712
    s_nop 0
    buffer_load_dwordx4 v2, s[8:11], s33 offen lds
    s_add_u32 m0, s38, 122880
    s_nop 0
    buffer_load_dwordx4 v1, s[12:15], s33 offen lds
    s_add_u32 m0, s38, 123904
    s_nop 0
    buffer_load_dwordx4 v2, s[12:15], s33 offen lds
    s_add_u32 s46, s46, 128
    s_and_b32 s46, s46, 2047
    s_waitcnt vmcnt(16)
    s_barrier
    s_waitcnt vmcnt(8)
    s_barrier
    s_waitcnt vmcnt(0)
    s_barrier
    s_endpgm

K1_MAIN:
    s_lshr_b32 s26, s28, 1
    s_and_b32 s27, s28, 1
    v_and_b32 v7, 31, v0
    v_lshrrev_b32 v8, 5, v0
    s_lshl_b32 s29, s31, 6
    s_lshl_b32 s32, s27, 5
    s_add_u32 s29, s29, s32
    v_add_u32 v9, s29, v7
    v_lshlrev_b32 v9, 1, v9
    v_mov_b32 v244, 0
    s_waitcnt lgkmcnt(0)
    s_mov_b32 s48, s4
    s_mov_b32 s49, s5

    global_load_ushort v10, v9, s[20:21]
    global_load_ushort v11, v9, s[22:23]
    global_load_ushort v12, v9, s[24:25]
    s_cmp_lg_u32 s28, 0
    s_cbranch_scc1 K1_NOCLR
    s_lshl_b32 s29, s31, 14
    s_lshl_b32 s32, s30, 10
    s_add_u32 s29, s29, s32
    s_add_u32 s29, s29, 8388608
    v_lshlrev_b32 v1, 4, v0
    v_add_u32 v1, s29, v1
    v_mov_b32 v32, 0
    v_mov_b32 v33, 0
    v_mov_b32 v34, 0
    v_mov_b32 v35, 0
    s_lshl_b32 s29, s31, 2
    v_mov_b32 v2, s29
    v_mov_b32 v3, 1
    global_store_dwordx4 v1, v[32:35], s[16:17] sc1
    s_waitcnt vmcnt(1)

    s_branch K1_CLRD
K1_NOCLR:
    s_waitcnt vmcnt(0)
K1_CLRD:
    v_lshrrev_b32 v1, 2, v7
    v_and_b32 v1, 1, v1
    v_lshlrev_b32 v1, 5, v1
    v_and_b32 v2, 3, v7
    v_add_u32 v1, v1, v2
    v_lshrrev_b32 v2, 3, v7
    v_lshlrev_b32 v2, 2, v2
    v_add_u32 v1, v1, v2
    s_lshl_b32 s29, s26, 6
    v_add_u32 v1, s29, v1
    v_lshrrev_b32 v2, 1, v1
    v_and_b32 v2, 7, v2
    v_xor_b32 v2, v8, v2
    v_lshlrev_b32 v2, 4, v2
    v_lshl_add_u32 v192, v1, 7, v2
    s_lshl_b32 s29, s27, 5
    v_add_u32 v1, s29, v7
    v_lshrrev_b32 v2, 1, v1
    v_and_b32 v2, 7, v2
    v_xor_b32 v2, v8, v2
    v_lshlrev_b32 v2, 4, v2
    v_lshl_add_u32 v196, v1, 7, v2
    v_add_u32 v196, 0x4000, v196

    v_xor_b32 v193, 32, v192
    v_xor_b32 v197, 32, v196
    v_xor_b32 v194, 64, v192
    v_xor_b32 v198, 64, v196
    v_xor_b32 v195, 96, v192
    v_xor_b32 v199, 96, v196
    v_add_u32 v200, 0x10000, v192
    v_add_u32 v201, 0x10000, v193
    v_add_u32 v202, 0x10000, v194
    v_add_u32 v203, 0x10000, v195
    v_add_u32 v204, 0x10000, v196
    v_add_u32 v205, 0x10000, v197
    v_add_u32 v206, 0x10000, v198
    v_add_u32 v207, 0x10000, v199
    v_mov_b32 v64, 0
    v_mov_b32 v65, 0
    v_mov_b32 v66, 0
    v_mov_b32 v67, 0
    v_mov_b32 v68, 0
    v_mov_b32 v69, 0
    v_mov_b32 v70, 0
    v_mov_b32 v71, 0
    v_mov_b32 v72, 0
    v_mov_b32 v73, 0
    v_mov_b32 v74, 0
    v_mov_b32 v75, 0
    v_mov_b32 v76, 0
    v_mov_b32 v77, 0
    v_mov_b32 v78, 0
    v_mov_b32 v79, 0
    v_mov_b32 v80, 0
    v_mov_b32 v81, 0
    v_mov_b32 v82, 0
    v_mov_b32 v83, 0
    v_mov_b32 v84, 0
    v_mov_b32 v85, 0
    v_mov_b32 v86, 0
    v_mov_b32 v87, 0
    v_mov_b32 v88, 0
    v_mov_b32 v89, 0
    v_mov_b32 v90, 0
    v_mov_b32 v91, 0
    v_mov_b32 v92, 0
    v_mov_b32 v93, 0
    v_mov_b32 v94, 0
    v_mov_b32 v95, 0
    v_mov_b32 v96, 0
    v_mov_b32 v97, 0
    v_mov_b32 v98, 0
    v_mov_b32 v99, 0
    v_mov_b32 v100, 0
    v_mov_b32 v101, 0
    v_mov_b32 v102, 0
    v_mov_b32 v103, 0
    v_mov_b32 v104, 0
    v_mov_b32 v105, 0
    v_mov_b32 v106, 0
    v_mov_b32 v107, 0
    v_mov_b32 v108, 0
    v_mov_b32 v109, 0
    v_mov_b32 v110, 0
    v_mov_b32 v111, 0
    v_mov_b32 v112, 0
    v_mov_b32 v113, 0
    v_mov_b32 v114, 0
    v_mov_b32 v115, 0
    v_mov_b32 v116, 0
    v_mov_b32 v117, 0
    v_mov_b32 v118, 0
    v_mov_b32 v119, 0
    v_mov_b32 v120, 0
    v_mov_b32 v121, 0
    v_mov_b32 v122, 0
    v_mov_b32 v123, 0
    v_mov_b32 v124, 0
    v_mov_b32 v125, 0
    v_mov_b32 v126, 0
    v_mov_b32 v127, 0
    v_lshlrev_b32 v10, 16, v10
    v_lshlrev_b32 v11, 16, v11
    v_lshlrev_b32 v12, 16, v12

    s_mov_b32 s36, 0x3fb8aa3b
    s_mov_b32 s37, 0x32a57060
    v_mul_f32 v14, s36, v12
    v_fma_f32 v15, v12, s36, -v14
    v_fma_f32 v15, v12, s37, v15
    v_exp_f32 v14, v14
    s_mov_b32 s36, 0x3f317218
    v_mul_f32 v15, s36, v15
    s_nop 0
    v_fma_f32 v13, v14, v15, v14

    v_cvt_pk_bf16_f32 v13, v13, v13
    v_lshlrev_b32 v13, 16, v13
    v_mul_f32 v14, v13, v10
    v_mul_f32 v15, v13, v11

    s_mov_b32 s36, 0x3fb8aa3b
    s_mov_b32 s37, 0x32a57060
    v_mul_f32 v17, s36, v14
    v_fma_f32 v18, v14, s36, -v17
    v_fma_f32 v18, v14, s37, v18
    v_exp_f32 v17, v17
    s_mov_b32 s36, 0x3f317218
    v_mul_f32 v18, s36, v18
    s_nop 0
    v_fma_f32 v16, v17, v18, v17

    v_mul_f32 v17, 0.15915494, v15
    v_fract_f32 v17, v17
    v_sin_f32 v18, v17
    v_cos_f32 v19, v17
    s_nop 0
    v_mul_f32 v20, v16, v19
    v_mul_f32 v21, v16, v18
    v_sub_f32 v22, 0, v21
    v_add_f32 v13, -1.0, v20
    v_mul_f32 v14, v13, v10
    v_fma_f32 v14, v21, v11, v14
    v_mul_f32 v15, v21, v10
    v_fma_f32 v15, -v13, v11, v15
    v_mul_f32 v16, v10, v10
    v_fma_f32 v16, v11, v11, v16
    v_rcp_f32 v17, v16
    s_nop 0
    v_fma_f32 v18, -v16, v17, 1.0
    v_fma_f32 v17, v17, v18, v17
    v_mul_f32 v23, v14, v17
    v_mul_f32 v24, v15, v17
    v_mul_f32 v25, v23, v20
    v_fma_f32 v25, -v24, v21, v25
    v_mul_f32 v26, v23, v21
    v_fma_f32 v26, v24, v20, v26
    v_add_f32 v208, v23, v23
    v_add_f32 v209, v23, v23
    v_mul_f32 v210, -2.0, v24
    v_mul_f32 v211, -2.0, v24
    v_mul_f32 v212, -2.0, v23
    v_mul_f32 v213, -2.0, v23

    v_mul_f32 v17, v21, v21
    v_fma_f32 v13, v20, v20, -v17
    v_add_f32 v17, v20, v20
    v_mul_f32 v14, v17, v21

    v_mov_b32 v214, v13
    v_mov_b32 v215, v13
    v_mov_b32 v216, v14
    v_mov_b32 v217, v14
    v_sub_f32 v218, 0, v14
    v_sub_f32 v219, 0, v14

    v_mul_f32 v17, v14, v14
    v_fma_f32 v15, v13, v13, -v17
    v_add_f32 v17, v13, v13
    v_mul_f32 v16, v17, v14

    v_mul_f32 v17, v16, v16
    v_fma_f32 v13, v15, v15, -v17
    v_add_f32 v17, v15, v15
    v_mul_f32 v14, v17, v16

    v_mul_f32 v17, v14, v14
    v_fma_f32 v15, v13, v13, -v17
    v_add_f32 v17, v13, v13
    v_mul_f32 v16, v17, v14

    v_mul_f32 v17, v16, v16
    v_fma_f32 v27, v15, v15, -v17
    v_add_f32 v17, v15, v15
    v_mul_f32 v28, v17, v16

    v_mul_f32 v17, v28, v28
    v_fma_f32 v13, v27, v27, -v17
    v_add_f32 v17, v27, v27
    v_mul_f32 v14, v17, v28

    v_mul_f32 v17, v14, v14
    v_fma_f32 v29, v13, v13, -v17
    v_add_f32 v17, v13, v13
    v_mul_f32 v30, v17, v14

    s_mov_b32 s35, 4
K1_LOOP:
    s_cmp_lg_u32 s28, 0
    s_cbranch_scc1 K1_NOSIG
    s_cmp_lg_u32 s35, 3
    s_cbranch_scc1 K1_NOSIG
    s_lshl_b32 s29, s31, 2
    v_mov_b32 v247, s29
    v_mov_b32 v248, 1
    s_waitcnt vmcnt(0)
    v_cmp_eq_u32 vcc, 0, v0
    s_and_saveexec_b64 s[36:37], vcc
    global_atomic_add v247, v248, s[18:19]
    s_mov_b64 exec, s[36:37]

    s_lshl_b32 s29, s2, 13
    v_lshlrev_b32 v1, 7, v0
    v_add_u32 v1, s29, v1
    global_load_dword v245, v1, s[40:41]
    global_load_dword v246, v1, s[42:43]

K1_NOSIG:
    s_barrier
    ds_read_b128 v[32:35], v192 offset:0
    ds_read_b128 v[40:43], v196 offset:0
    ds_read_b128 v[44:47], v196 offset:8192
    ds_read_b128 v[36:39], v192 offset:2048
    ds_read_b128 v[48:51], v193 offset:0
    ds_read_b128 v[56:59], v197 offset:0
    ds_read_b128 v[60:63], v197 offset:8192
    ds_read_b128 v[52:55], v193 offset:2048
    s_waitcnt lgkmcnt(4)
    v_mfma_f32_32x32x16_bf16 v[64:79], v[32:35], v[40:43], v[64:79]
    v_mfma_f32_32x32x16_bf16 v[80:95], v[32:35], v[44:47], v[80:95]
    v_mfma_f32_32x32x16_bf16 v[96:111], v[36:39], v[40:43], v[96:111]
    v_mfma_f32_32x32x16_bf16 v[112:127], v[36:39], v[44:47], v[112:127]
    ds_read_b128 v[32:35], v194 offset:0
    ds_read_b128 v[40:43], v198 offset:0
    ds_read_b128 v[44:47], v198 offset:8192
    ds_read_b128 v[36:39], v194 offset:2048
    s_waitcnt lgkmcnt(4)
    v_mfma_f32_32x32x16_bf16 v[64:79], v[48:51], v[56:59], v[64:79]
    v_mfma_f32_32x32x16_bf16 v[80:95], v[48:51], v[60:63], v[80:95]
    v_mfma_f32_32x32x16_bf16 v[96:111], v[52:55], v[56:59], v[96:111]
    v_mfma_f32_32x32x16_bf16 v[112:127], v[52:55], v[60:63], v[112:127]
    ds_read_b128 v[48:51], v195 offset:0
    ds_read_b128 v[56:59], v199 offset:0
    ds_read_b128 v[60:63], v199 offset:8192
    ds_read_b128 v[52:55], v195 offset:2048
    s_waitcnt lgkmcnt(4)
    v_mfma_f32_32x32x16_bf16 v[64:79], v[32:35], v[40:43], v[64:79]
    v_mfma_f32_32x32x16_bf16 v[80:95], v[32:35], v[44:47], v[80:95]
    v_mfma_f32_32x32x16_bf16 v[96:111], v[36:39], v[40:43], v[96:111]
    v_mfma_f32_32x32x16_bf16 v[112:127], v[36:39], v[44:47], v[112:127]
    s_waitcnt lgkmcnt(0)
    v_mfma_f32_32x32x16_bf16 v[64:79], v[48:51], v[56:59], v[64:79]
    v_mfma_f32_32x32x16_bf16 v[80:95], v[48:51], v[60:63], v[80:95]
    v_mfma_f32_32x32x16_bf16 v[96:111], v[52:55], v[56:59], v[96:111]
    v_mfma_f32_32x32x16_bf16 v[112:127], v[52:55], v[60:63], v[112:127]
    s_barrier
    ds_read_b128 v[32:35], v192 offset:32768
    ds_read_b128 v[40:43], v196 offset:32768
    ds_read_b128 v[44:47], v196 offset:40960
    ds_read_b128 v[36:39], v192 offset:34816
    ds_read_b128 v[48:51], v193 offset:32768
    ds_read_b128 v[56:59], v197 offset:32768
    ds_read_b128 v[60:63], v197 offset:40960
    ds_read_b128 v[52:55], v193 offset:34816
    s_waitcnt lgkmcnt(4)
    v_mfma_f32_32x32x16_bf16 v[64:79], v[32:35], v[40:43], v[64:79]
    v_mfma_f32_32x32x16_bf16 v[80:95], v[32:35], v[44:47], v[80:95]
    v_mfma_f32_32x32x16_bf16 v[96:111], v[36:39], v[40:43], v[96:111]
    v_mfma_f32_32x32x16_bf16 v[112:127], v[36:39], v[44:47], v[112:127]
    ds_read_b128 v[32:35], v194 offset:32768
    ds_read_b128 v[40:43], v198 offset:32768
    ds_read_b128 v[44:47], v198 offset:40960
    ds_read_b128 v[36:39], v194 offset:34816
    s_waitcnt lgkmcnt(4)
    v_mfma_f32_32x32x16_bf16 v[64:79], v[48:51], v[56:59], v[64:79]
    v_mfma_f32_32x32x16_bf16 v[80:95], v[48:51], v[60:63], v[80:95]
    v_mfma_f32_32x32x16_bf16 v[96:111], v[52:55], v[56:59], v[96:111]
    v_mfma_f32_32x32x16_bf16 v[112:127], v[52:55], v[60:63], v[112:127]
    ds_read_b128 v[48:51], v195 offset:32768
    ds_read_b128 v[56:59], v199 offset:32768
    ds_read_b128 v[60:63], v199 offset:40960
    ds_read_b128 v[52:55], v195 offset:34816
    s_waitcnt lgkmcnt(4)
    v_mfma_f32_32x32x16_bf16 v[64:79], v[32:35], v[40:43], v[64:79]
    v_mfma_f32_32x32x16_bf16 v[80:95], v[32:35], v[44:47], v[80:95]
    v_mfma_f32_32x32x16_bf16 v[96:111], v[36:39], v[40:43], v[96:111]
    v_mfma_f32_32x32x16_bf16 v[112:127], v[36:39], v[44:47], v[112:127]
    s_waitcnt lgkmcnt(0)
    v_mfma_f32_32x32x16_bf16 v[64:79], v[48:51], v[56:59], v[64:79]
    v_mfma_f32_32x32x16_bf16 v[80:95], v[48:51], v[60:63], v[80:95]
    v_mfma_f32_32x32x16_bf16 v[96:111], v[52:55], v[56:59], v[96:111]
    v_mfma_f32_32x32x16_bf16 v[112:127], v[52:55], v[60:63], v[112:127]
    s_barrier
    ds_read_b128 v[32:35], v200 offset:0
    ds_read_b128 v[40:43], v204 offset:0
    ds_read_b128 v[44:47], v204 offset:8192
    ds_read_b128 v[36:39], v200 offset:2048
    ds_read_b128 v[48:51], v201 offset:0
    ds_read_b128 v[56:59], v205 offset:0
    ds_read_b128 v[60:63], v205 offset:8192
    ds_read_b128 v[52:55], v201 offset:2048
    s_waitcnt lgkmcnt(4)
    v_mfma_f32_32x32x16_bf16 v[64:79], v[32:35], v[40:43], v[64:79]
    v_mfma_f32_32x32x16_bf16 v[80:95], v[32:35], v[44:47], v[80:95]
    v_mfma_f32_32x32x16_bf16 v[96:111], v[36:39], v[40:43], v[96:111]
    v_mfma_f32_32x32x16_bf16 v[112:127], v[36:39], v[44:47], v[112:127]
    ds_read_b128 v[32:35], v202 offset:0
    ds_read_b128 v[40:43], v206 offset:0
    ds_read_b128 v[44:47], v206 offset:8192
    ds_read_b128 v[36:39], v202 offset:2048
    s_waitcnt lgkmcnt(4)
    v_mfma_f32_32x32x16_bf16 v[64:79], v[48:51], v[56:59], v[64:79]
    v_mfma_f32_32x32x16_bf16 v[80:95], v[48:51], v[60:63], v[80:95]
    v_mfma_f32_32x32x16_bf16 v[96:111], v[52:55], v[56:59], v[96:111]
    v_mfma_f32_32x32x16_bf16 v[112:127], v[52:55], v[60:63], v[112:127]
    ds_read_b128 v[48:51], v203 offset:0
    ds_read_b128 v[56:59], v207 offset:0
    ds_read_b128 v[60:63], v207 offset:8192
    ds_read_b128 v[52:55], v203 offset:2048
    s_waitcnt lgkmcnt(4)
    v_mfma_f32_32x32x16_bf16 v[64:79], v[32:35], v[40:43], v[64:79]
    v_mfma_f32_32x32x16_bf16 v[80:95], v[32:35], v[44:47], v[80:95]
    v_mfma_f32_32x32x16_bf16 v[96:111], v[36:39], v[40:43], v[96:111]
    v_mfma_f32_32x32x16_bf16 v[112:127], v[36:39], v[44:47], v[112:127]
    s_waitcnt lgkmcnt(0)
    v_mfma_f32_32x32x16_bf16 v[64:79], v[48:51], v[56:59], v[64:79]
    v_mfma_f32_32x32x16_bf16 v[80:95], v[48:51], v[60:63], v[80:95]
    v_mfma_f32_32x32x16_bf16 v[96:111], v[52:55], v[56:59], v[96:111]
    v_mfma_f32_32x32x16_bf16 v[112:127], v[52:55], v[60:63], v[112:127]
    s_barrier
    ds_read_b128 v[32:35], v200 offset:32768
    ds_read_b128 v[40:43], v204 offset:32768
    ds_read_b128 v[44:47], v204 offset:40960
    ds_read_b128 v[36:39], v200 offset:34816
    ds_read_b128 v[48:51], v201 offset:32768
    ds_read_b128 v[56:59], v205 offset:32768
    ds_read_b128 v[60:63], v205 offset:40960
    ds_read_b128 v[52:55], v201 offset:34816
    s_waitcnt lgkmcnt(4)
    v_mfma_f32_32x32x16_bf16 v[64:79], v[32:35], v[40:43], v[64:79]
    v_mfma_f32_32x32x16_bf16 v[80:95], v[32:35], v[44:47], v[80:95]
    v_mfma_f32_32x32x16_bf16 v[96:111], v[36:39], v[40:43], v[96:111]
    v_mfma_f32_32x32x16_bf16 v[112:127], v[36:39], v[44:47], v[112:127]
    ds_read_b128 v[32:35], v202 offset:32768
    ds_read_b128 v[40:43], v206 offset:32768
    ds_read_b128 v[44:47], v206 offset:40960
    ds_read_b128 v[36:39], v202 offset:34816
    s_waitcnt lgkmcnt(4)
    v_mfma_f32_32x32x16_bf16 v[64:79], v[48:51], v[56:59], v[64:79]
    v_mfma_f32_32x32x16_bf16 v[80:95], v[48:51], v[60:63], v[80:95]
    v_mfma_f32_32x32x16_bf16 v[96:111], v[52:55], v[56:59], v[96:111]
    v_mfma_f32_32x32x16_bf16 v[112:127], v[52:55], v[60:63], v[112:127]
    ds_read_b128 v[48:51], v203 offset:32768
    ds_read_b128 v[56:59], v207 offset:32768
    ds_read_b128 v[60:63], v207 offset:40960
    ds_read_b128 v[52:55], v203 offset:34816
    s_waitcnt lgkmcnt(4)
    v_mfma_f32_32x32x16_bf16 v[64:79], v[32:35], v[40:43], v[64:79]
    v_mfma_f32_32x32x16_bf16 v[80:95], v[32:35], v[44:47], v[80:95]
    v_mfma_f32_32x32x16_bf16 v[96:111], v[36:39], v[40:43], v[96:111]
    v_mfma_f32_32x32x16_bf16 v[112:127], v[36:39], v[44:47], v[112:127]
    s_waitcnt lgkmcnt(0)
    v_mfma_f32_32x32x16_bf16 v[64:79], v[48:51], v[56:59], v[64:79]
    v_mfma_f32_32x32x16_bf16 v[80:95], v[48:51], v[60:63], v[80:95]
    v_mfma_f32_32x32x16_bf16 v[96:111], v[52:55], v[56:59], v[96:111]
    v_mfma_f32_32x32x16_bf16 v[112:127], v[52:55], v[60:63], v[112:127]
    s_sub_u32 s35, s35, 1
    s_cmp_lg_u32 s35, 0
    s_cbranch_scc1 K1_LOOP
    s_nop 15
    s_nop 3

    s_lshl_b32 s29, s31, 2
    v_mov_b32 v34, s29
    global_load_dword v35, v34, s[18:19] sc1

    v_fmac_f32 v65, v20, v64
    v_fmac_f32 v81, v20, v80
    v_fmac_f32 v65, v22, v80
    v_fmac_f32 v81, v21, v64
    v_fmac_f32 v66, v20, v65
    v_fmac_f32 v82, v20, v81
    v_fmac_f32 v66, v22, v81
    v_fmac_f32 v82, v21, v65
    v_fmac_f32 v67, v20, v66
    v_fmac_f32 v83, v20, v82
    v_fmac_f32 v67, v22, v82
    v_fmac_f32 v83, v21, v66
    v_fmac_f32 v68, v20, v67
    v_fmac_f32 v84, v20, v83
    v_fmac_f32 v68, v22, v83
    v_fmac_f32 v84, v21, v67
    v_fmac_f32 v69, v20, v68
    v_fmac_f32 v85, v20, v84
    v_fmac_f32 v69, v22, v84
    v_fmac_f32 v85, v21, v68
    v_fmac_f32 v70, v20, v69
    v_fmac_f32 v86, v20, v85
    v_fmac_f32 v70, v22, v85
    v_fmac_f32 v86, v21, v69
    v_fmac_f32 v71, v20, v70
    v_fmac_f32 v87, v20, v86
    v_fmac_f32 v71, v22, v86
    v_fmac_f32 v87, v21, v70
    v_fmac_f32 v72, v20, v71
    v_fmac_f32 v88, v20, v87
    v_fmac_f32 v72, v22, v87
    v_fmac_f32 v88, v21, v71
    v_fmac_f32 v73, v20, v72
    v_fmac_f32 v89, v20, v88
    v_fmac_f32 v73, v22, v88
    v_fmac_f32 v89, v21, v72
    v_fmac_f32 v74, v20, v73
    v_fmac_f32 v90, v20, v89
    v_fmac_f32 v74, v22, v89
    v_fmac_f32 v90, v21, v73
    v_fmac_f32 v75, v20, v74
    v_fmac_f32 v91, v20, v90
    v_fmac_f32 v75, v22, v90
    v_fmac_f32 v91, v21, v74
    v_fmac_f32 v76, v20, v75
    v_fmac_f32 v92, v20, v91
    v_fmac_f32 v76, v22, v91
    v_fmac_f32 v92, v21, v75
    v_fmac_f32 v77, v20, v76
    v_fmac_f32 v93, v20, v92
    v_fmac_f32 v77, v22, v92
    v_fmac_f32 v93, v21, v76
    v_fmac_f32 v78, v20, v77
    v_fmac_f32 v94, v20, v93
    v_fmac_f32 v78, v22, v93
    v_fmac_f32 v94, v21, v77
    v_fmac_f32 v79, v20, v78
    v_fmac_f32 v95, v20, v94
    v_fmac_f32 v79, v22, v94
    v_fmac_f32 v95, v21, v78
    v_fmac_f32 v96, v20, v79
    v_fmac_f32 v112, v20, v95
    v_fmac_f32 v96, v22, v95
    v_fmac_f32 v112, v21, v79
    v_fmac_f32 v97, v20, v96
    v_fmac_f32 v113, v20, v112
    v_fmac_f32 v97, v22, v112
    v_fmac_f32 v113, v21, v96
    v_fmac_f32 v98, v20, v97
    v_fmac_f32 v114, v20, v113
    v_fmac_f32 v98, v22, v113
    v_fmac_f32 v114, v21, v97
    v_fmac_f32 v99, v20, v98
    v_fmac_f32 v115, v20, v114
    v_fmac_f32 v99, v22, v114
    v_fmac_f32 v115, v21, v98
    v_fmac_f32 v100, v20, v99
    v_fmac_f32 v116, v20, v115
    v_fmac_f32 v100, v22, v115
    v_fmac_f32 v116, v21, v99
    v_fmac_f32 v101, v20, v100
    v_fmac_f32 v117, v20, v116
    v_fmac_f32 v101, v22, v116
    v_fmac_f32 v117, v21, v100
    v_fmac_f32 v102, v20, v101
    v_fmac_f32 v118, v20, v117
    v_fmac_f32 v102, v22, v117
    v_fmac_f32 v118, v21, v101
    v_fmac_f32 v103, v20, v102
    v_fmac_f32 v119, v20, v118
    v_fmac_f32 v103, v22, v118
    v_fmac_f32 v119, v21, v102
    v_fmac_f32 v104, v20, v103
    v_fmac_f32 v120, v20, v119
    v_fmac_f32 v104, v22, v119
    v_fmac_f32 v120, v21, v103
    v_fmac_f32 v105, v20, v104
    v_fmac_f32 v121, v20, v120
    v_fmac_f32 v105, v22, v120
    v_fmac_f32 v121, v21, v104
    v_fmac_f32 v106, v20, v105
    v_fmac_f32 v122, v20, v121
    v_fmac_f32 v106, v22, v121
    v_fmac_f32 v122, v21, v105
    v_fmac_f32 v107, v20, v106
    v_fmac_f32 v123, v20, v122
    v_fmac_f32 v107, v22, v122
    v_fmac_f32 v123, v21, v106
    v_fmac_f32 v108, v20, v107
    v_fmac_f32 v124, v20, v123
    v_fmac_f32 v108, v22, v123
    v_fmac_f32 v124, v21, v107
    v_fmac_f32 v109, v20, v108
    v_fmac_f32 v125, v20, v124
    v_fmac_f32 v109, v22, v124
    v_fmac_f32 v125, v21, v108
    v_fmac_f32 v110, v20, v109
    v_fmac_f32 v126, v20, v125
    v_fmac_f32 v110, v22, v125
    v_fmac_f32 v126, v21, v109
    v_fmac_f32 v111, v20, v110
    v_fmac_f32 v127, v20, v126
    v_fmac_f32 v111, v22, v126
    v_fmac_f32 v127, v21, v110
    s_lshl_b32 s29, s27, 5
    v_add_u32 v9, s29, v7
    v_lshlrev_b32 v10, 3, v9
    v_add_u32 v10, 131072, v10
    s_lshl_b32 s29, s26, 1
    v_add_u32 v11, s29, v8
    v_lshlrev_b32 v11, 9, v11
    v_add_u32 v11, v11, v10
    ds_write2_b32 v11, v111, v127 offset0:0 offset1:1
    s_mov_b32 s35, 0x40000

K1_POLL:
    s_waitcnt vmcnt(0)
    v_readfirstlane_b32 s29, v35
    s_nop 3
    s_cmp_ge_u32 s29, 16
    s_cbranch_scc1 K1_POLL_DONE
    s_sub_u32 s35, s35, 1
    s_cmp_eq_u32 s35, 0
    s_cbranch_scc1 K1_POLL_DONE
    s_sleep 2
    global_load_dword v35, v34, s[18:19] sc1
    s_branch K1_POLL

K1_POLL_DONE:
    s_waitcnt lgkmcnt(0)
    s_barrier
    ds_read_b64 v[12:13], v10
    ds_read_b64 v[14:15], v10 offset:512
    ds_read_b64 v[16:17], v10 offset:1024
    ds_read_b64 v[18:19], v10 offset:1536
    s_lshl_b32 s29, s31, 14
    s_add_u32 s29, s29, 8388608
    v_lshlrev_b32 v9, 4, v9
    v_add_u32 v9, s29, v9
    s_lshl_b32 s29, s30, 10
    v_add_u32 v11, s29, v9
    s_waitcnt lgkmcnt(0)

    v_fma_f32 v36, v12, v27, v14
    v_fma_f32 v37, v12, v28, v15
    v_fma_f32 v36, -v13, v28, v36
    v_fma_f32 v37, v13, v27, v37

    v_fma_f32 v38, v36, v27, v16
    v_fma_f32 v39, v36, v28, v17
    v_fma_f32 v38, -v37, v28, v38
    v_fma_f32 v39, v37, v27, v39

    v_fma_f32 v32, v38, v27, v18
    v_fma_f32 v34, v38, v28, v19
    v_fma_f32 v32, -v39, v28, v32
    v_fma_f32 v34, v39, v27, v34

    v_mov_b32 v33, -1
    v_mov_b32 v35, -1
    s_cmp_lg_u32 s26, 0
    s_cbranch_scc1 K1_NOPUB
    v_cmp_gt_u32 vcc, 32, v0
    s_and_saveexec_b64 s[36:37], vcc
    global_store_dwordx4 v11, v[32:35], s[16:17] sc1
    s_mov_b64 exec, s[36:37]

K1_NOPUB:
    v_pk_mul_f32 v[128:129], v[64:65], v[208:209]
    v_pk_fma_f32 v[128:129], v[80:81], v[210:211], v[128:129]
    v_pk_mul_f32 v[80:81], v[80:81], v[212:213]
    v_pk_fma_f32 v[80:81], v[64:65], v[210:211], v[80:81]
    v_pk_mul_f32 v[130:131], v[66:67], v[208:209]
    v_pk_fma_f32 v[130:131], v[82:83], v[210:211], v[130:131]
    v_pk_mul_f32 v[82:83], v[82:83], v[212:213]
    v_pk_fma_f32 v[82:83], v[66:67], v[210:211], v[82:83]
    v_pk_mul_f32 v[132:133], v[68:69], v[208:209]
    v_pk_fma_f32 v[132:133], v[84:85], v[210:211], v[132:133]
    v_pk_mul_f32 v[84:85], v[84:85], v[212:213]
    v_pk_fma_f32 v[84:85], v[68:69], v[210:211], v[84:85]
    v_pk_mul_f32 v[134:135], v[70:71], v[208:209]
    v_pk_fma_f32 v[134:135], v[86:87], v[210:211], v[134:135]
    v_pk_mul_f32 v[86:87], v[86:87], v[212:213]
    v_pk_fma_f32 v[86:87], v[70:71], v[210:211], v[86:87]
    v_pk_mul_f32 v[136:137], v[72:73], v[208:209]
    v_pk_fma_f32 v[136:137], v[88:89], v[210:211], v[136:137]
    v_pk_mul_f32 v[88:89], v[88:89], v[212:213]
    v_pk_fma_f32 v[88:89], v[72:73], v[210:211], v[88:89]
    v_pk_mul_f32 v[138:139], v[74:75], v[208:209]
    v_pk_fma_f32 v[138:139], v[90:91], v[210:211], v[138:139]
    v_pk_mul_f32 v[90:91], v[90:91], v[212:213]
    v_pk_fma_f32 v[90:91], v[74:75], v[210:211], v[90:91]
    v_pk_mul_f32 v[140:141], v[76:77], v[208:209]
    v_pk_fma_f32 v[140:141], v[92:93], v[210:211], v[140:141]
    v_pk_mul_f32 v[92:93], v[92:93], v[212:213]
    v_pk_fma_f32 v[92:93], v[76:77], v[210:211], v[92:93]
    v_pk_mul_f32 v[142:143], v[78:79], v[208:209]
    v_pk_fma_f32 v[142:143], v[94:95], v[210:211], v[142:143]
    v_pk_mul_f32 v[94:95], v[94:95], v[212:213]
    v_pk_fma_f32 v[94:95], v[78:79], v[210:211], v[94:95]
    v_pk_mul_f32 v[144:145], v[96:97], v[208:209]
    v_pk_fma_f32 v[144:145], v[112:113], v[210:211], v[144:145]
    v_pk_mul_f32 v[112:113], v[112:113], v[212:213]
    v_pk_fma_f32 v[112:113], v[96:97], v[210:211], v[112:113]
    v_pk_mul_f32 v[146:147], v[98:99], v[208:209]
    v_pk_fma_f32 v[146:147], v[114:115], v[210:211], v[146:147]
    v_pk_mul_f32 v[114:115], v[114:115], v[212:213]
    v_pk_fma_f32 v[114:115], v[98:99], v[210:211], v[114:115]
    v_pk_mul_f32 v[148:149], v[100:101], v[208:209]
    v_pk_fma_f32 v[148:149], v[116:117], v[210:211], v[148:149]
    v_pk_mul_f32 v[116:117], v[116:117], v[212:213]
    v_pk_fma_f32 v[116:117], v[100:101], v[210:211], v[116:117]
    v_pk_mul_f32 v[150:151], v[102:103], v[208:209]
    v_pk_fma_f32 v[150:151], v[118:119], v[210:211], v[150:151]
    v_pk_mul_f32 v[118:119], v[118:119], v[212:213]
    v_pk_fma_f32 v[118:119], v[102:103], v[210:211], v[118:119]
    v_pk_mul_f32 v[152:153], v[104:105], v[208:209]
    v_pk_fma_f32 v[152:153], v[120:121], v[210:211], v[152:153]
    v_pk_mul_f32 v[120:121], v[120:121], v[212:213]
    v_pk_fma_f32 v[120:121], v[104:105], v[210:211], v[120:121]
    v_pk_mul_f32 v[154:155], v[106:107], v[208:209]
    v_pk_fma_f32 v[154:155], v[122:123], v[210:211], v[154:155]
    v_pk_mul_f32 v[122:123], v[122:123], v[212:213]
    v_pk_fma_f32 v[122:123], v[106:107], v[210:211], v[122:123]
    v_pk_mul_f32 v[156:157], v[108:109], v[208:209]
    v_pk_fma_f32 v[156:157], v[124:125], v[210:211], v[156:157]
    v_pk_mul_f32 v[124:125], v[124:125], v[212:213]
    v_pk_fma_f32 v[124:125], v[108:109], v[210:211], v[124:125]
    v_pk_mul_f32 v[158:159], v[110:111], v[208:209]
    v_pk_fma_f32 v[158:159], v[126:127], v[210:211], v[158:159]
    v_pk_mul_f32 v[126:127], v[126:127], v[212:213]
    v_pk_fma_f32 v[126:127], v[110:111], v[210:211], v[126:127]
    v_mov_b32 v64, 1.0
    v_mov_b32 v65, v20
    v_mov_b32 v160, 0
    v_mov_b32 v161, v22

    v_pk_mul_f32 v[66:67], v[64:65], v[214:215]
    v_pk_mul_f32 v[162:163], v[160:161], v[214:215]
    v_pk_fma_f32 v[66:67], v[160:161], v[216:217], v[66:67]
    v_pk_fma_f32 v[162:163], v[64:65], v[218:219], v[162:163]
    v_pk_mul_f32 v[68:69], v[66:67], v[214:215]
    v_pk_mul_f32 v[164:165], v[162:163], v[214:215]
    v_pk_fma_f32 v[68:69], v[162:163], v[216:217], v[68:69]
    v_pk_fma_f32 v[164:165], v[66:67], v[218:219], v[164:165]
    v_pk_mul_f32 v[70:71], v[68:69], v[214:215]
    v_pk_mul_f32 v[166:167], v[164:165], v[214:215]
    v_pk_fma_f32 v[70:71], v[164:165], v[216:217], v[70:71]
    v_pk_fma_f32 v[166:167], v[68:69], v[218:219], v[166:167]
    v_pk_mul_f32 v[72:73], v[70:71], v[214:215]
    v_pk_mul_f32 v[168:169], v[166:167], v[214:215]
    v_pk_fma_f32 v[72:73], v[166:167], v[216:217], v[72:73]
    v_pk_fma_f32 v[168:169], v[70:71], v[218:219], v[168:169]
    v_pk_mul_f32 v[74:75], v[72:73], v[214:215]
    v_pk_mul_f32 v[170:171], v[168:169], v[214:215]
    v_pk_fma_f32 v[74:75], v[168:169], v[216:217], v[74:75]
    v_pk_fma_f32 v[170:171], v[72:73], v[218:219], v[170:171]
    v_pk_mul_f32 v[76:77], v[74:75], v[214:215]
    v_pk_mul_f32 v[172:173], v[170:171], v[214:215]
    v_pk_fma_f32 v[76:77], v[170:171], v[216:217], v[76:77]
    v_pk_fma_f32 v[172:173], v[74:75], v[218:219], v[172:173]
    v_pk_mul_f32 v[78:79], v[76:77], v[214:215]
    v_pk_mul_f32 v[174:175], v[172:173], v[214:215]
    v_pk_fma_f32 v[78:79], v[172:173], v[216:217], v[78:79]
    v_pk_fma_f32 v[174:175], v[76:77], v[218:219], v[174:175]
    v_pk_mul_f32 v[96:97], v[78:79], v[214:215]
    v_pk_mul_f32 v[176:177], v[174:175], v[214:215]
    v_pk_fma_f32 v[96:97], v[174:175], v[216:217], v[96:97]
    v_pk_fma_f32 v[176:177], v[78:79], v[218:219], v[176:177]
    v_pk_mul_f32 v[98:99], v[96:97], v[214:215]
    v_pk_mul_f32 v[178:179], v[176:177], v[214:215]
    v_pk_fma_f32 v[98:99], v[176:177], v[216:217], v[98:99]
    v_pk_fma_f32 v[178:179], v[96:97], v[218:219], v[178:179]
    v_pk_mul_f32 v[100:101], v[98:99], v[214:215]
    v_pk_mul_f32 v[180:181], v[178:179], v[214:215]
    v_pk_fma_f32 v[100:101], v[178:179], v[216:217], v[100:101]
    v_pk_fma_f32 v[180:181], v[98:99], v[218:219], v[180:181]
    v_pk_mul_f32 v[102:103], v[100:101], v[214:215]
    v_pk_mul_f32 v[182:183], v[180:181], v[214:215]
    v_pk_fma_f32 v[102:103], v[180:181], v[216:217], v[102:103]
    v_pk_fma_f32 v[182:183], v[100:101], v[218:219], v[182:183]
    v_pk_mul_f32 v[104:105], v[102:103], v[214:215]
    v_pk_mul_f32 v[184:185], v[182:183], v[214:215]
    v_pk_fma_f32 v[104:105], v[182:183], v[216:217], v[104:105]
    v_pk_fma_f32 v[184:185], v[102:103], v[218:219], v[184:185]
    v_pk_mul_f32 v[106:107], v[104:105], v[214:215]
    v_pk_mul_f32 v[186:187], v[184:185], v[214:215]
    v_pk_fma_f32 v[106:107], v[184:185], v[216:217], v[106:107]
    v_pk_fma_f32 v[186:187], v[104:105], v[218:219], v[186:187]
    v_pk_mul_f32 v[108:109], v[106:107], v[214:215]
    v_pk_mul_f32 v[188:189], v[186:187], v[214:215]
    v_pk_fma_f32 v[108:109], v[186:187], v[216:217], v[108:109]
    v_pk_fma_f32 v[188:189], v[106:107], v[218:219], v[188:189]
    v_pk_mul_f32 v[110:111], v[108:109], v[214:215]
    v_pk_mul_f32 v[190:191], v[188:189], v[214:215]
    v_pk_fma_f32 v[110:111], v[188:189], v[216:217], v[110:111]
    v_pk_fma_f32 v[190:191], v[108:109], v[218:219], v[190:191]
    v_mov_b32 v36, 0
    v_mov_b32 v37, 0
    s_cmp_eq_u32 s30, 0
    s_cbranch_scc1 K1_CARRY_DONE
    v_add_u32 v40, 0x1000, v9
    v_add_u32 v41, 0x2000, v9
    v_add_u32 v42, 0x3000, v9
    s_mov_b32 s35, 0x40000

K1_GPOLL:
    global_load_dwordx4 v[192:195], v9, s[16:17] offset:0 sc1
    s_cmp_le_u32 s30, 1
    s_cbranch_scc1 K1_GP_ISSUED
    global_load_dwordx4 v[196:199], v9, s[16:17] offset:1024 sc1
    s_cmp_le_u32 s30, 2
    s_cbranch_scc1 K1_GP_ISSUED
    global_load_dwordx4 v[200:203], v9, s[16:17] offset:2048 sc1
    s_cmp_le_u32 s30, 3
    s_cbranch_scc1 K1_GP_ISSUED
    global_load_dwordx4 v[204:207], v9, s[16:17] offset:3072 sc1
    s_cmp_le_u32 s30, 4
    s_cbranch_scc1 K1_GP_ISSUED
    global_load_dwordx4 v[208:211], v40, s[16:17] offset:0 sc1
    s_cmp_le_u32 s30, 5
    s_cbranch_scc1 K1_GP_ISSUED
    global_load_dwordx4 v[212:215], v40, s[16:17] offset:1024 sc1
    s_cmp_le_u32 s30, 6
    s_cbranch_scc1 K1_GP_ISSUED
    global_load_dwordx4 v[216:219], v40, s[16:17] offset:2048 sc1
    s_cmp_le_u32 s30, 7
    s_cbranch_scc1 K1_GP_ISSUED
    global_load_dwordx4 v[220:223], v40, s[16:17] offset:3072 sc1
    s_cmp_le_u32 s30, 8
    s_cbranch_scc1 K1_GP_ISSUED
    global_load_dwordx4 v[224:227], v41, s[16:17] offset:0 sc1
    s_cmp_le_u32 s30, 9
    s_cbranch_scc1 K1_GP_ISSUED
    global_load_dwordx4 v[228:231], v41, s[16:17] offset:1024 sc1
    s_cmp_le_u32 s30, 10
    s_cbranch_scc1 K1_GP_ISSUED
    global_load_dwordx4 v[232:235], v41, s[16:17] offset:2048 sc1
    s_cmp_le_u32 s30, 11
    s_cbranch_scc1 K1_GP_ISSUED
    global_load_dwordx4 v[236:239], v41, s[16:17] offset:3072 sc1
    s_cmp_le_u32 s30, 12
    s_cbranch_scc1 K1_GP_ISSUED
    global_load_dwordx4 v[240:243], v42, s[16:17] offset:0 sc1
    s_cmp_le_u32 s30, 13
    s_cbranch_scc1 K1_GP_ISSUED
    global_load_dwordx4 v[244:247], v42, s[16:17] offset:1024 sc1
    s_cmp_le_u32 s30, 14
    s_cbranch_scc1 K1_GP_ISSUED
    global_load_dwordx4 v[248:251], v42, s[16:17] offset:2048 sc1
K1_GP_ISSUED:
    s_waitcnt vmcnt(0)
    v_mov_b32 v38, -1
    v_and_b32 v38, v38, v193
    v_and_b32 v38, v38, v195
    s_cmp_le_u32 s30, 1
    s_cbranch_scc1 K1_GP_CHECKED
    v_and_b32 v38, v38, v197
    v_and_b32 v38, v38, v199
    s_cmp_le_u32 s30, 2
    s_cbranch_scc1 K1_GP_CHECKED
    v_and_b32 v38, v38, v201
    v_and_b32 v38, v38, v203
    s_cmp_le_u32 s30, 3
    s_cbranch_scc1 K1_GP_CHECKED
    v_and_b32 v38, v38, v205
    v_and_b32 v38, v38, v207
    s_cmp_le_u32 s30, 4
    s_cbranch_scc1 K1_GP_CHECKED
    v_and_b32 v38, v38, v209
    v_and_b32 v38, v38, v211
    s_cmp_le_u32 s30, 5
    s_cbranch_scc1 K1_GP_CHECKED
    v_and_b32 v38, v38, v213
    v_and_b32 v38, v38, v215
    s_cmp_le_u32 s30, 6
    s_cbranch_scc1 K1_GP_CHECKED
    v_and_b32 v38, v38, v217
    v_and_b32 v38, v38, v219
    s_cmp_le_u32 s30, 7
    s_cbranch_scc1 K1_GP_CHECKED
    v_and_b32 v38, v38, v221
    v_and_b32 v38, v38, v223
    s_cmp_le_u32 s30, 8
    s_cbranch_scc1 K1_GP_CHECKED
    v_and_b32 v38, v38, v225
    v_and_b32 v38, v38, v227
    s_cmp_le_u32 s30, 9
    s_cbranch_scc1 K1_GP_CHECKED
    v_and_b32 v38, v38, v229
    v_and_b32 v38, v38, v231
    s_cmp_le_u32 s30, 10
    s_cbranch_scc1 K1_GP_CHECKED
    v_and_b32 v38, v38, v233
    v_and_b32 v38, v38, v235
    s_cmp_le_u32 s30, 11
    s_cbranch_scc1 K1_GP_CHECKED
    v_and_b32 v38, v38, v237
    v_and_b32 v38, v38, v239
    s_cmp_le_u32 s30, 12
    s_cbranch_scc1 K1_GP_CHECKED
    v_and_b32 v38, v38, v241
    v_and_b32 v38, v38, v243
    s_cmp_le_u32 s30, 13
    s_cbranch_scc1 K1_GP_CHECKED
    v_and_b32 v38, v38, v245
    v_and_b32 v38, v38, v247
    s_cmp_le_u32 s30, 14
    s_cbranch_scc1 K1_GP_CHECKED
    v_and_b32 v38, v38, v249
    v_and_b32 v38, v38, v251
K1_GP_CHECKED:
    v_cmp_ne_u32 vcc, -1, v38
    s_cbranch_vccz K1_GP_DONE
    s_sub_u32 s35, s35, 1
    s_cmp_eq_u32 s35, 0
    s_cbranch_scc1 K1_GP_DONE
    s_sleep 1
    s_branch K1_GPOLL

K1_GP_DONE:
    v_mov_b32 v36, v192
    v_mov_b32 v37, v194
    s_cmp_le_u32 s30, 1
    s_cbranch_scc1 K1_CARRY_DONE
    v_fma_f32 v38, v36, v29, v196
    v_fma_f32 v39, v36, v30, v198
    v_fma_f32 v38, -v37, v30, v38
    v_fma_f32 v39, v37, v29, v39

    v_mov_b32 v36, v38
    v_mov_b32 v37, v39
    s_cmp_le_u32 s30, 2
    s_cbranch_scc1 K1_CARRY_DONE
    v_fma_f32 v38, v36, v29, v200
    v_fma_f32 v39, v36, v30, v202
    v_fma_f32 v38, -v37, v30, v38
    v_fma_f32 v39, v37, v29, v39

    v_mov_b32 v36, v38
    v_mov_b32 v37, v39
    s_cmp_le_u32 s30, 3
    s_cbranch_scc1 K1_CARRY_DONE
    v_fma_f32 v38, v36, v29, v204
    v_fma_f32 v39, v36, v30, v206
    v_fma_f32 v38, -v37, v30, v38
    v_fma_f32 v39, v37, v29, v39

    v_mov_b32 v36, v38
    v_mov_b32 v37, v39
    s_cmp_le_u32 s30, 4
    s_cbranch_scc1 K1_CARRY_DONE
    v_fma_f32 v38, v36, v29, v208
    v_fma_f32 v39, v36, v30, v210
    v_fma_f32 v38, -v37, v30, v38
    v_fma_f32 v39, v37, v29, v39

    v_mov_b32 v36, v38
    v_mov_b32 v37, v39
    s_cmp_le_u32 s30, 5
    s_cbranch_scc1 K1_CARRY_DONE
    v_fma_f32 v38, v36, v29, v212
    v_fma_f32 v39, v36, v30, v214
    v_fma_f32 v38, -v37, v30, v38
    v_fma_f32 v39, v37, v29, v39

    v_mov_b32 v36, v38
    v_mov_b32 v37, v39
    s_cmp_le_u32 s30, 6
    s_cbranch_scc1 K1_CARRY_DONE
    v_fma_f32 v38, v36, v29, v216
    v_fma_f32 v39, v36, v30, v218
    v_fma_f32 v38, -v37, v30, v38
    v_fma_f32 v39, v37, v29, v39

    v_mov_b32 v36, v38
    v_mov_b32 v37, v39
    s_cmp_le_u32 s30, 7
    s_cbranch_scc1 K1_CARRY_DONE
    v_fma_f32 v38, v36, v29, v220
    v_fma_f32 v39, v36, v30, v222
    v_fma_f32 v38, -v37, v30, v38
    v_fma_f32 v39, v37, v29, v39

    v_mov_b32 v36, v38
    v_mov_b32 v37, v39
    s_cmp_le_u32 s30, 8
    s_cbranch_scc1 K1_CARRY_DONE
    v_fma_f32 v38, v36, v29, v224
    v_fma_f32 v39, v36, v30, v226
    v_fma_f32 v38, -v37, v30, v38
    v_fma_f32 v39, v37, v29, v39

    v_mov_b32 v36, v38
    v_mov_b32 v37, v39
    s_cmp_le_u32 s30, 9
    s_cbranch_scc1 K1_CARRY_DONE
    v_fma_f32 v38, v36, v29, v228
    v_fma_f32 v39, v36, v30, v230
    v_fma_f32 v38, -v37, v30, v38
    v_fma_f32 v39, v37, v29, v39

    v_mov_b32 v36, v38
    v_mov_b32 v37, v39
    s_cmp_le_u32 s30, 10
    s_cbranch_scc1 K1_CARRY_DONE
    v_fma_f32 v38, v36, v29, v232
    v_fma_f32 v39, v36, v30, v234
    v_fma_f32 v38, -v37, v30, v38
    v_fma_f32 v39, v37, v29, v39

    v_mov_b32 v36, v38
    v_mov_b32 v37, v39
    s_cmp_le_u32 s30, 11
    s_cbranch_scc1 K1_CARRY_DONE
    v_fma_f32 v38, v36, v29, v236
    v_fma_f32 v39, v36, v30, v238
    v_fma_f32 v38, -v37, v30, v38
    v_fma_f32 v39, v37, v29, v39

    v_mov_b32 v36, v38
    v_mov_b32 v37, v39
    s_cmp_le_u32 s30, 12
    s_cbranch_scc1 K1_CARRY_DONE
    v_fma_f32 v38, v36, v29, v240
    v_fma_f32 v39, v36, v30, v242
    v_fma_f32 v38, -v37, v30, v38
    v_fma_f32 v39, v37, v29, v39

    v_mov_b32 v36, v38
    v_mov_b32 v37, v39
    s_cmp_le_u32 s30, 13
    s_cbranch_scc1 K1_CARRY_DONE
    v_fma_f32 v38, v36, v29, v244
    v_fma_f32 v39, v36, v30, v246
    v_fma_f32 v38, -v37, v30, v38
    v_fma_f32 v39, v37, v29, v39

    v_mov_b32 v36, v38
    v_mov_b32 v37, v39
    s_cmp_le_u32 s30, 14
    s_cbranch_scc1 K1_CARRY_DONE
    v_fma_f32 v38, v36, v29, v248
    v_fma_f32 v39, v36, v30, v250
    v_fma_f32 v38, -v37, v30, v38
    v_fma_f32 v39, v37, v29, v39

    v_mov_b32 v36, v38
    v_mov_b32 v37, v39
K1_CARRY_DONE:
    v_fma_f32 v38, v36, v27, v12
    v_fma_f32 v39, v36, v28, v13
    v_fma_f32 v38, -v37, v28, v38
    v_fma_f32 v39, v37, v27, v39

    v_fma_f32 v40, v38, v27, v14
    v_fma_f32 v41, v38, v28, v15
    v_fma_f32 v40, -v39, v28, v40
    v_fma_f32 v41, v39, v27, v41

    v_fma_f32 v42, v40, v27, v16
    v_fma_f32 v43, v40, v28, v17
    v_fma_f32 v42, -v41, v28, v42
    v_fma_f32 v43, v41, v27, v43

    v_cmp_lt_u32 vcc, 31, v0
    s_cmp_lg_u32 s26, 0
    s_cbranch_scc1 K1_SEL_HI
    v_cndmask_b32 v44, v36, v38, vcc
    v_cndmask_b32 v45, v37, v39, vcc
    s_branch K1_SEL_DONE

K1_SEL_HI:
    s_nop 0
    v_cndmask_b32 v44, v40, v42, vcc
    v_cndmask_b32 v45, v41, v43, vcc

K1_SEL_DONE:
    v_mul_f32 v46, v25, v44
    v_fma_f32 v46, -v26, v45, v46
    v_mul_f32 v47, v25, v45
    v_fma_f32 v47, v26, v44, v47
    v_add_f32 v12, v46, v46
    v_add_f32 v13, v46, v46
    v_mul_f32 v14, -2.0, v47
    v_mul_f32 v15, -2.0, v47
    v_add_f32 v16, v47, v47
    v_add_f32 v17, v47, v47

    v_pk_fma_f32 v[128:129], v[64:65], v[12:13], v[128:129]
    v_pk_fma_f32 v[80:81], v[64:65], v[14:15], v[80:81]
    v_pk_fma_f32 v[128:129], v[160:161], v[16:17], v[128:129]
    v_pk_fma_f32 v[80:81], v[160:161], v[12:13], v[80:81]
    v_cvt_pk_bf16_f32 v32, v128, v129
    v_cvt_pk_bf16_f32 v48, v80, v81
    v_pk_fma_f32 v[130:131], v[66:67], v[12:13], v[130:131]
    v_pk_fma_f32 v[82:83], v[66:67], v[14:15], v[82:83]
    v_pk_fma_f32 v[130:131], v[162:163], v[16:17], v[130:131]
    v_pk_fma_f32 v[82:83], v[162:163], v[12:13], v[82:83]
    v_cvt_pk_bf16_f32 v33, v130, v131
    v_cvt_pk_bf16_f32 v49, v82, v83
    v_pk_fma_f32 v[132:133], v[68:69], v[12:13], v[132:133]
    v_pk_fma_f32 v[84:85], v[68:69], v[14:15], v[84:85]
    v_pk_fma_f32 v[132:133], v[164:165], v[16:17], v[132:133]
    v_pk_fma_f32 v[84:85], v[164:165], v[12:13], v[84:85]
    v_cvt_pk_bf16_f32 v34, v132, v133
    v_cvt_pk_bf16_f32 v50, v84, v85
    v_pk_fma_f32 v[134:135], v[70:71], v[12:13], v[134:135]
    v_pk_fma_f32 v[86:87], v[70:71], v[14:15], v[86:87]
    v_pk_fma_f32 v[134:135], v[166:167], v[16:17], v[134:135]
    v_pk_fma_f32 v[86:87], v[166:167], v[12:13], v[86:87]
    v_cvt_pk_bf16_f32 v35, v134, v135
    v_cvt_pk_bf16_f32 v51, v86, v87
    v_pk_fma_f32 v[136:137], v[72:73], v[12:13], v[136:137]
    v_pk_fma_f32 v[88:89], v[72:73], v[14:15], v[88:89]
    v_pk_fma_f32 v[136:137], v[168:169], v[16:17], v[136:137]
    v_pk_fma_f32 v[88:89], v[168:169], v[12:13], v[88:89]
    v_cvt_pk_bf16_f32 v36, v136, v137
    v_cvt_pk_bf16_f32 v52, v88, v89
    v_pk_fma_f32 v[138:139], v[74:75], v[12:13], v[138:139]
    v_pk_fma_f32 v[90:91], v[74:75], v[14:15], v[90:91]
    v_pk_fma_f32 v[138:139], v[170:171], v[16:17], v[138:139]
    v_pk_fma_f32 v[90:91], v[170:171], v[12:13], v[90:91]
    v_cvt_pk_bf16_f32 v37, v138, v139
    v_cvt_pk_bf16_f32 v53, v90, v91
    v_pk_fma_f32 v[140:141], v[76:77], v[12:13], v[140:141]
    v_pk_fma_f32 v[92:93], v[76:77], v[14:15], v[92:93]
    v_pk_fma_f32 v[140:141], v[172:173], v[16:17], v[140:141]
    v_pk_fma_f32 v[92:93], v[172:173], v[12:13], v[92:93]
    v_cvt_pk_bf16_f32 v38, v140, v141
    v_cvt_pk_bf16_f32 v54, v92, v93
    v_pk_fma_f32 v[142:143], v[78:79], v[12:13], v[142:143]
    v_pk_fma_f32 v[94:95], v[78:79], v[14:15], v[94:95]
    v_pk_fma_f32 v[142:143], v[174:175], v[16:17], v[142:143]
    v_pk_fma_f32 v[94:95], v[174:175], v[12:13], v[94:95]
    v_cvt_pk_bf16_f32 v39, v142, v143
    v_cvt_pk_bf16_f32 v55, v94, v95
    v_pk_fma_f32 v[144:145], v[96:97], v[12:13], v[144:145]
    v_pk_fma_f32 v[112:113], v[96:97], v[14:15], v[112:113]
    v_pk_fma_f32 v[144:145], v[176:177], v[16:17], v[144:145]
    v_pk_fma_f32 v[112:113], v[176:177], v[12:13], v[112:113]
    v_cvt_pk_bf16_f32 v40, v144, v145
    v_cvt_pk_bf16_f32 v56, v112, v113
    v_pk_fma_f32 v[146:147], v[98:99], v[12:13], v[146:147]
    v_pk_fma_f32 v[114:115], v[98:99], v[14:15], v[114:115]
    v_pk_fma_f32 v[146:147], v[178:179], v[16:17], v[146:147]
    v_pk_fma_f32 v[114:115], v[178:179], v[12:13], v[114:115]
    v_cvt_pk_bf16_f32 v41, v146, v147
    v_cvt_pk_bf16_f32 v57, v114, v115
    v_pk_fma_f32 v[148:149], v[100:101], v[12:13], v[148:149]
    v_pk_fma_f32 v[116:117], v[100:101], v[14:15], v[116:117]
    v_pk_fma_f32 v[148:149], v[180:181], v[16:17], v[148:149]
    v_pk_fma_f32 v[116:117], v[180:181], v[12:13], v[116:117]
    v_cvt_pk_bf16_f32 v42, v148, v149
    v_cvt_pk_bf16_f32 v58, v116, v117
    v_pk_fma_f32 v[150:151], v[102:103], v[12:13], v[150:151]
    v_pk_fma_f32 v[118:119], v[102:103], v[14:15], v[118:119]
    v_pk_fma_f32 v[150:151], v[182:183], v[16:17], v[150:151]
    v_pk_fma_f32 v[118:119], v[182:183], v[12:13], v[118:119]
    v_cvt_pk_bf16_f32 v43, v150, v151
    v_cvt_pk_bf16_f32 v59, v118, v119
    v_pk_fma_f32 v[152:153], v[104:105], v[12:13], v[152:153]
    v_pk_fma_f32 v[120:121], v[104:105], v[14:15], v[120:121]
    v_pk_fma_f32 v[152:153], v[184:185], v[16:17], v[152:153]
    v_pk_fma_f32 v[120:121], v[184:185], v[12:13], v[120:121]
    v_cvt_pk_bf16_f32 v44, v152, v153
    v_cvt_pk_bf16_f32 v60, v120, v121
    v_pk_fma_f32 v[154:155], v[106:107], v[12:13], v[154:155]
    v_pk_fma_f32 v[122:123], v[106:107], v[14:15], v[122:123]
    v_pk_fma_f32 v[154:155], v[186:187], v[16:17], v[154:155]
    v_pk_fma_f32 v[122:123], v[186:187], v[12:13], v[122:123]
    v_cvt_pk_bf16_f32 v45, v154, v155
    v_cvt_pk_bf16_f32 v61, v122, v123
    v_pk_fma_f32 v[156:157], v[108:109], v[12:13], v[156:157]
    v_pk_fma_f32 v[124:125], v[108:109], v[14:15], v[124:125]
    v_pk_fma_f32 v[156:157], v[188:189], v[16:17], v[156:157]
    v_pk_fma_f32 v[124:125], v[188:189], v[12:13], v[124:125]
    v_cvt_pk_bf16_f32 v46, v156, v157
    v_cvt_pk_bf16_f32 v62, v124, v125
    v_pk_fma_f32 v[158:159], v[110:111], v[12:13], v[158:159]
    v_pk_fma_f32 v[126:127], v[110:111], v[14:15], v[126:127]
    v_pk_fma_f32 v[158:159], v[190:191], v[16:17], v[158:159]
    v_pk_fma_f32 v[126:127], v[190:191], v[12:13], v[126:127]
    v_cvt_pk_bf16_f32 v47, v158, v159
    v_cvt_pk_bf16_f32 v63, v126, v127
    s_lshl_b32 s29, s27, 5
    v_add_u32 v9, s29, v7
    v_mul_u32_u24 v9, 272, v9
    s_lshl_b32 s29, s26, 7
    v_lshlrev_b32 v10, 6, v8
    v_add3_u32 v9, v9, v10, s29

    ds_write_b128 v9, v[32:35] offset:0
    ds_write_b128 v9, v[36:39] offset:16
    ds_write_b128 v9, v[40:43] offset:32
    ds_write_b128 v9, v[44:47] offset:48
    ds_write_b128 v9, v[48:51] offset:17408
    ds_write_b128 v9, v[52:55] offset:17424
    ds_write_b128 v9, v[56:59] offset:17440
    ds_write_b128 v9, v[60:63] offset:17456
    v_lshrrev_b32 v10, 4, v0
    v_lshlrev_b32 v10, 3, v10
    v_lshrrev_b32 v11, 2, v0
    v_and_b32 v11, 3, v11
    v_add_u32 v10, v10, v11
    v_mul_u32_u24 v10, 272, v10
    v_and_b32 v11, 3, v0
    v_lshlrev_b32 v11, 3, v11
    s_lshl_b32 s29, s28, 6
    v_add3_u32 v10, v10, v11, s29
    v_and_b32 v11, 15, v0
    v_lshlrev_b32 v11, 12, v11
    v_lshrrev_b32 v12, 4, v0
    v_lshlrev_b32 v12, 4, v12
    v_add_u32 v11, v11, v12
    v_add_u32 v12, 0x10000, v11
    s_lshl_b32 s29, s30, 19
    s_lshl_b32 s35, s28, 17
    s_add_u32 s29, s29, s35
    s_lshl_b32 s35, s31, 7
    s_add_u32 s29, s29, s35
    s_mov_b32 s40, s16
    s_and_b32 s41, s17, 0xffff
    s_mov_b32 s42, 8388608
    s_mov_b32 s43, 0x00020000
    s_waitcnt lgkmcnt(0)
    s_barrier

    ds_read_b64_tr_b16 v[64:65], v10 offset:0
    ds_read_b64_tr_b16 v[66:67], v10 offset:1088
    ds_read_b64_tr_b16 v[68:69], v10 offset:8704
    ds_read_b64_tr_b16 v[70:71], v10 offset:9792
    ds_read_b64_tr_b16 v[72:73], v10 offset:17408
    ds_read_b64_tr_b16 v[74:75], v10 offset:18496
    ds_read_b64_tr_b16 v[76:77], v10 offset:26112
    ds_read_b64_tr_b16 v[78:79], v10 offset:27200
    ds_read_b64_tr_b16 v[80:81], v10 offset:32
    ds_read_b64_tr_b16 v[82:83], v10 offset:1120
    ds_read_b64_tr_b16 v[84:85], v10 offset:8736
    ds_read_b64_tr_b16 v[86:87], v10 offset:9824
    ds_read_b64_tr_b16 v[88:89], v10 offset:17440
    ds_read_b64_tr_b16 v[90:91], v10 offset:18528
    ds_read_b64_tr_b16 v[92:93], v10 offset:26144
    ds_read_b64_tr_b16 v[94:95], v10 offset:27232
    s_waitcnt lgkmcnt(14)
    buffer_store_dwordx4 v[64:67], v11, s[40:43], s29 offen offset:0 sc1
    s_waitcnt lgkmcnt(12)
    buffer_store_dwordx4 v[68:71], v11, s[40:43], s29 offen offset:64 sc1
    s_waitcnt lgkmcnt(10)
    buffer_store_dwordx4 v[72:75], v11, s[40:43], s29 offen offset:2048 sc1
    s_waitcnt lgkmcnt(8)
    buffer_store_dwordx4 v[76:79], v11, s[40:43], s29 offen offset:2112 sc1
    s_waitcnt lgkmcnt(6)
    buffer_store_dwordx4 v[80:83], v12, s[40:43], s29 offen offset:0 sc1
    s_waitcnt lgkmcnt(4)
    buffer_store_dwordx4 v[84:87], v12, s[40:43], s29 offen offset:64 sc1
    s_waitcnt lgkmcnt(2)
    buffer_store_dwordx4 v[88:91], v12, s[40:43], s29 offen offset:2048 sc1
    s_waitcnt lgkmcnt(0)
    buffer_store_dwordx4 v[92:95], v12, s[40:43], s29 offen offset:2112 sc1
K1_END:
    s_endpgm
.globl ssm_k2_kernel
.p2align 8
.type ssm_k2_kernel,@function
ssm_k2_kernel:
    s_cmp_ge_u32 s2, 256
    s_cbranch_scc1 K2_END
    s_load_dwordx2 s[4:5], s[0:1], 88
    s_load_dwordx2 s[8:9], s[0:1], 40
    s_load_dwordx2 s[12:13], s[0:1], 48
    s_load_dwordx2 s[16:17], s[0:1], 0
    s_load_dwordx2 s[20:21], s[0:1], 72
    s_load_dwordx2 s[24:25], s[0:1], 64

    s_and_b32 s26, s2, 7
    s_lshr_b32 s27, s2, 3
    s_and_b32 s30, s26, 3
    s_lshl_b32 s30, s30, 2
    s_and_b32 s31, s27, 3
    s_add_u32 s30, s30, s31
    s_lshr_b32 s31, s26, 2
    s_lshl_b32 s31, s31, 3
    s_lshr_b32 s27, s27, 2
    s_add_u32 s31, s31, s27
    v_lshrrev_b32 v1, 6, v0
    v_and_b32 v0, 63, v0
    v_readfirstlane_b32 s28, v1
    s_nop 3
    s_cmp_lt_u32 s28, 4
    s_cbranch_scc1 K2_MAIN
    s_setprio 0
    s_sub_u32 s28, s28, 4
    v_lshrrev_b32 v7, 4, v0
    v_xor_b32 v7, v7, v0
    v_and_b32 v7, 7, v7
    v_lshlrev_b32 v7, 4, v7
    v_lshrrev_b32 v8, 3, v0
    v_lshl_add_u32 v1, v8, 12, v7
    v_xor_b32 v2, 64, v1
    v_add_u32 v2, 0x8000, v2
    v_add_u32 v3, 0x10000, v1
    v_add_u32 v4, 0x10000, v2
    v_lshl_add_u32 v5, v8, 11, v7
    v_xor_b32 v6, 64, v5
    v_add_u32 v6, 0x4000, v6
    s_lshl_b32 s32, s30, 19
    s_lshl_b32 s33, s28, 17
    s_add_u32 s32, s32, s33
    s_add_u32 s36, s32, 2048
    s_lshl_b32 s33, s31, 17
    s_lshl_b32 s34, s28, 15
    s_add_u32 s33, s33, s34
    s_lshl_b32 s34, s28, 12
    s_lshl_b32 s38, s28, 11
    s_mov_b32 s44, s32
    s_mov_b32 s45, s33
    s_lshr_b32 s46, s2, 3
    s_and_b32 s46, s46, 15
    s_lshl_b32 s46, s46, 7
    s_waitcnt lgkmcnt(0)

    s_and_b32 s5, s5, 0xffff
    s_mov_b32 s6, 8388608
    s_mov_b32 s7, 0x00020000
    s_and_b32 s9, s9, 0xffff
    s_mov_b32 s10, 2097152
    s_mov_b32 s11, 0x00020000
    s_and_b32 s13, s13, 0xffff
    s_mov_b32 s14, 2097152
    s_mov_b32 s15, 0x00020000
    s_add_u32 m0, s34, 0
    s_nop 0
    buffer_load_dwordx4 v1, s[4:7], s32 offen lds
    s_add_u32 m0, s34, 1024
    s_nop 0
    buffer_load_dwordx4 v2, s[4:7], s32 offen lds
    s_add_u32 m0, s34, 2048
    s_nop 0
    buffer_load_dwordx4 v3, s[4:7], s32 offen lds
    s_add_u32 m0, s34, 3072
    s_nop 0
    buffer_load_dwordx4 v4, s[4:7], s32 offen lds
    s_add_u32 m0, s38, 32768
    s_nop 0
    buffer_load_dwordx4 v5, s[8:11], s33 offen lds
    s_add_u32 m0, s38, 33792
    s_nop 0
    buffer_load_dwordx4 v6, s[8:11], s33 offen lds
    s_add_u32 m0, s34, 16384
    s_nop 0
    buffer_load_dwordx4 v1, s[4:7], s36 offen lds
    s_add_u32 m0, s34, 17408
    s_nop 0
    buffer_load_dwordx4 v2, s[4:7], s36 offen lds
    s_add_u32 m0, s34, 18432
    s_nop 0
    buffer_load_dwordx4 v3, s[4:7], s36 offen lds
    s_add_u32 m0, s34, 19456
    s_nop 0
    buffer_load_dwordx4 v4, s[4:7], s36 offen lds
    s_add_u32 m0, s38, 40960
    s_nop 0
    buffer_load_dwordx4 v5, s[12:15], s33 offen lds
    s_add_u32 m0, s38, 41984
    s_nop 0
    buffer_load_dwordx4 v6, s[12:15], s33 offen lds
    s_add_u32 s32, s32, 128
    s_add_u32 s36, s36, 128
    s_add_u32 s33, s33, 128
    s_add_u32 m0, s34, 49152
    s_nop 0
    buffer_load_dwordx4 v1, s[4:7], s32 offen lds
    s_add_u32 m0, s34, 50176
    s_nop 0
    buffer_load_dwordx4 v2, s[4:7], s32 offen lds
    s_add_u32 m0, s34, 51200
    s_nop 0
    buffer_load_dwordx4 v3, s[4:7], s32 offen lds
    s_add_u32 m0, s34, 52224
    s_nop 0
    buffer_load_dwordx4 v4, s[4:7], s32 offen lds
    s_add_u32 m0, s38, 81920
    s_nop 0
    buffer_load_dwordx4 v5, s[8:11], s33 offen lds
    s_add_u32 m0, s38, 82944
    s_nop 0
    buffer_load_dwordx4 v6, s[8:11], s33 offen lds
    s_add_u32 m0, s34, 65536
    s_nop 0
    buffer_load_dwordx4 v1, s[4:7], s36 offen lds
    s_add_u32 m0, s34, 66560
    s_nop 0
    buffer_load_dwordx4 v2, s[4:7], s36 offen lds
    s_add_u32 m0, s34, 67584
    s_nop 0
    buffer_load_dwordx4 v3, s[4:7], s36 offen lds
    s_add_u32 m0, s34, 68608
    s_nop 0
    buffer_load_dwordx4 v4, s[4:7], s36 offen lds
    s_add_u32 m0, s38, 90112
    s_nop 0
    buffer_load_dwordx4 v5, s[12:15], s33 offen lds
    s_add_u32 m0, s38, 91136
    s_nop 0
    buffer_load_dwordx4 v6, s[12:15], s33 offen lds
    s_add_u32 s32, s32, 128
    s_add_u32 s36, s36, 128
    s_add_u32 s33, s33, 128
    s_mov_b32 s35, 4
K2_PLOOP:
    s_waitcnt vmcnt(12)
    s_barrier
    s_add_u32 m0, s34, 98304
    s_nop 0
    buffer_load_dwordx4 v1, s[4:7], s32 offen lds
    s_add_u32 m0, s34, 99328
    s_nop 0
    buffer_load_dwordx4 v2, s[4:7], s32 offen lds
    s_add_u32 m0, s34, 100352
    s_nop 0
    buffer_load_dwordx4 v3, s[4:7], s32 offen lds
    s_add_u32 m0, s34, 101376
    s_nop 0
    buffer_load_dwordx4 v4, s[4:7], s32 offen lds
    s_add_u32 m0, s38, 131072
    s_nop 0
    buffer_load_dwordx4 v5, s[8:11], s33 offen lds
    s_add_u32 m0, s38, 132096
    s_nop 0
    buffer_load_dwordx4 v6, s[8:11], s33 offen lds
    s_add_u32 m0, s34, 114688
    s_nop 0
    buffer_load_dwordx4 v1, s[4:7], s36 offen lds
    s_add_u32 m0, s34, 115712
    s_nop 0
    buffer_load_dwordx4 v2, s[4:7], s36 offen lds
    s_add_u32 m0, s34, 116736
    s_nop 0
    buffer_load_dwordx4 v3, s[4:7], s36 offen lds
    s_add_u32 m0, s34, 117760
    s_nop 0
    buffer_load_dwordx4 v4, s[4:7], s36 offen lds
    s_add_u32 m0, s38, 139264
    s_nop 0
    buffer_load_dwordx4 v5, s[12:15], s33 offen lds
    s_add_u32 m0, s38, 140288
    s_nop 0
    buffer_load_dwordx4 v6, s[12:15], s33 offen lds
    s_add_u32 s32, s32, 128
    s_add_u32 s36, s36, 128
    s_add_u32 s33, s33, 128
    s_waitcnt vmcnt(12)
    s_barrier
    s_add_u32 m0, s34, 0
    s_nop 0
    buffer_load_dwordx4 v1, s[4:7], s32 offen lds
    s_add_u32 m0, s34, 1024
    s_nop 0
    buffer_load_dwordx4 v2, s[4:7], s32 offen lds
    s_add_u32 m0, s34, 2048
    s_nop 0
    buffer_load_dwordx4 v3, s[4:7], s32 offen lds
    s_add_u32 m0, s34, 3072
    s_nop 0
    buffer_load_dwordx4 v4, s[4:7], s32 offen lds
    s_add_u32 m0, s38, 32768
    s_nop 0
    buffer_load_dwordx4 v5, s[8:11], s33 offen lds
    s_add_u32 m0, s38, 33792
    s_nop 0
    buffer_load_dwordx4 v6, s[8:11], s33 offen lds
    s_add_u32 m0, s34, 16384
    s_nop 0
    buffer_load_dwordx4 v1, s[4:7], s36 offen lds
    s_add_u32 m0, s34, 17408
    s_nop 0
    buffer_load_dwordx4 v2, s[4:7], s36 offen lds
    s_add_u32 m0, s34, 18432
    s_nop 0
    buffer_load_dwordx4 v3, s[4:7], s36 offen lds
    s_add_u32 m0, s34, 19456
    s_nop 0
    buffer_load_dwordx4 v4, s[4:7], s36 offen lds
    s_add_u32 m0, s38, 40960
    s_nop 0
    buffer_load_dwordx4 v5, s[12:15], s33 offen lds
    s_add_u32 m0, s38, 41984
    s_nop 0
    buffer_load_dwordx4 v6, s[12:15], s33 offen lds
    s_add_u32 s32, s32, 128
    s_add_u32 s36, s36, 128
    s_add_u32 s33, s33, 128
    s_waitcnt vmcnt(12)
    s_barrier
    s_add_u32 m0, s34, 49152
    s_nop 0
    buffer_load_dwordx4 v1, s[4:7], s32 offen lds
    s_add_u32 m0, s34, 50176
    s_nop 0
    buffer_load_dwordx4 v2, s[4:7], s32 offen lds
    s_add_u32 m0, s34, 51200
    s_nop 0
    buffer_load_dwordx4 v3, s[4:7], s32 offen lds
    s_add_u32 m0, s34, 52224
    s_nop 0
    buffer_load_dwordx4 v4, s[4:7], s32 offen lds
    s_add_u32 m0, s38, 81920
    s_nop 0
    buffer_load_dwordx4 v5, s[8:11], s33 offen lds
    s_add_u32 m0, s38, 82944
    s_nop 0
    buffer_load_dwordx4 v6, s[8:11], s33 offen lds
    s_add_u32 m0, s34, 65536
    s_nop 0
    buffer_load_dwordx4 v1, s[4:7], s36 offen lds
    s_add_u32 m0, s34, 66560
    s_nop 0
    buffer_load_dwordx4 v2, s[4:7], s36 offen lds
    s_add_u32 m0, s34, 67584
    s_nop 0
    buffer_load_dwordx4 v3, s[4:7], s36 offen lds
    s_add_u32 m0, s34, 68608
    s_nop 0
    buffer_load_dwordx4 v4, s[4:7], s36 offen lds
    s_add_u32 m0, s38, 90112
    s_nop 0
    buffer_load_dwordx4 v5, s[12:15], s33 offen lds
    s_add_u32 m0, s38, 91136
    s_nop 0
    buffer_load_dwordx4 v6, s[12:15], s33 offen lds
    s_add_u32 s32, s32, 128
    s_add_u32 s36, s36, 128
    s_add_u32 s33, s33, 128
    s_sub_u32 s35, s35, 1
    s_cmp_lg_u32 s35, 0
    s_cbranch_scc1 K2_PLOOP

    s_waitcnt vmcnt(12)
    s_barrier
    s_add_u32 m0, s34, 98304
    s_nop 0
    buffer_load_dwordx4 v1, s[4:7], s32 offen lds
    s_add_u32 m0, s34, 99328
    s_nop 0
    buffer_load_dwordx4 v2, s[4:7], s32 offen lds
    s_add_u32 m0, s34, 100352
    s_nop 0
    buffer_load_dwordx4 v3, s[4:7], s32 offen lds
    s_add_u32 m0, s34, 101376
    s_nop 0
    buffer_load_dwordx4 v4, s[4:7], s32 offen lds
    s_add_u32 m0, s38, 131072
    s_nop 0
    buffer_load_dwordx4 v5, s[8:11], s33 offen lds
    s_add_u32 m0, s38, 132096
    s_nop 0
    buffer_load_dwordx4 v6, s[8:11], s33 offen lds
    s_add_u32 m0, s34, 114688
    s_nop 0
    buffer_load_dwordx4 v1, s[4:7], s36 offen lds
    s_add_u32 m0, s34, 115712
    s_nop 0
    buffer_load_dwordx4 v2, s[4:7], s36 offen lds
    s_add_u32 m0, s34, 116736
    s_nop 0
    buffer_load_dwordx4 v3, s[4:7], s36 offen lds
    s_add_u32 m0, s34, 117760
    s_nop 0
    buffer_load_dwordx4 v4, s[4:7], s36 offen lds
    s_add_u32 m0, s38, 139264
    s_nop 0
    buffer_load_dwordx4 v5, s[12:15], s33 offen lds
    s_add_u32 m0, s38, 140288
    s_nop 0
    buffer_load_dwordx4 v6, s[12:15], s33 offen lds
    s_add_u32 s32, s32, 128
    s_add_u32 s36, s36, 128
    s_add_u32 s33, s33, 128
    s_waitcnt vmcnt(12)
    s_barrier
    s_add_u32 m0, s34, 0
    s_nop 0
    buffer_load_dwordx4 v1, s[4:7], s32 offen lds
    s_add_u32 m0, s34, 1024
    s_nop 0
    buffer_load_dwordx4 v2, s[4:7], s32 offen lds
    s_add_u32 m0, s34, 2048
    s_nop 0
    buffer_load_dwordx4 v3, s[4:7], s32 offen lds
    s_add_u32 m0, s34, 3072
    s_nop 0
    buffer_load_dwordx4 v4, s[4:7], s32 offen lds
    s_add_u32 m0, s38, 32768
    s_nop 0
    buffer_load_dwordx4 v5, s[8:11], s33 offen lds
    s_add_u32 m0, s38, 33792
    s_nop 0
    buffer_load_dwordx4 v6, s[8:11], s33 offen lds
    s_add_u32 m0, s34, 16384
    s_nop 0
    buffer_load_dwordx4 v1, s[4:7], s36 offen lds
    s_add_u32 m0, s34, 17408
    s_nop 0
    buffer_load_dwordx4 v2, s[4:7], s36 offen lds
    s_add_u32 m0, s34, 18432
    s_nop 0
    buffer_load_dwordx4 v3, s[4:7], s36 offen lds
    s_add_u32 m0, s34, 19456
    s_nop 0
    buffer_load_dwordx4 v4, s[4:7], s36 offen lds
    s_add_u32 m0, s38, 40960
    s_nop 0
    buffer_load_dwordx4 v5, s[12:15], s33 offen lds
    s_add_u32 m0, s38, 41984
    s_nop 0
    buffer_load_dwordx4 v6, s[12:15], s33 offen lds
    s_add_u32 s32, s32, 128
    s_add_u32 s36, s36, 128
    s_add_u32 s33, s33, 128
    s_waitcnt vmcnt(12)
    s_barrier
    s_waitcnt vmcnt(0)
    s_barrier
    s_endpgm

K2_MAIN:
    s_and_b32 s26, s28, 1
    s_lshr_b32 s27, s28, 1
    v_and_b32 v14, 31, v0
    v_lshrrev_b32 v15, 5, v0

    v_and_b32 v14, 15, v0
    v_lshrrev_b32 v15, 4, v0

    v_lshrrev_b32 v7, 1, v14
    v_and_b32 v7, 7, v7
    v_xor_b32 v7, v15, v7
    v_lshlrev_b32 v7, 4, v7
    s_lshl_b32 s29, s27, 14
    s_lshl_b32 s32, s26, 13
    s_add_u32 s29, s29, s32
    v_lshlrev_b32 v8, 7, v14
    v_add3_u32 v144, v8, v7, s29
    s_lshl_b32 s29, s27, 13
    s_add_u32 s29, s29, 32768
    v_add3_u32 v148, v8, v7, s29

    v_xor_b32 v145, 64, v144
    v_xor_b32 v149, 64, v148
    v_xor_b32 v146, 0, v144
    v_xor_b32 v150, 0, v148
    v_xor_b32 v147, 64, v144
    v_xor_b32 v151, 64, v148
    v_add_u32 v152, 49152, v144
    v_add_u32 v153, 49152, v145
    v_add_u32 v154, 49152, v146
    v_add_u32 v155, 49152, v147
    v_add_u32 v156, 49152, v148
    v_add_u32 v157, 49152, v149
    v_add_u32 v158, 49152, v150
    v_add_u32 v159, 49152, v151
    v_add_u32 v160, 98304, v144
    v_add_u32 v161, 98304, v145
    v_add_u32 v162, 98304, v146
    v_add_u32 v163, 98304, v147
    v_add_u32 v164, 98304, v148
    v_add_u32 v165, 98304, v149
    v_add_u32 v166, 98304, v150
    v_add_u32 v167, 98304, v151
    s_waitcnt lgkmcnt(0)
    s_and_b32 s17, s17, 0xffff
    s_mov_b32 s18, 4194304
    s_mov_b32 s19, 0x00020000
    s_and_b32 s21, s21, 0xffff
    s_mov_b32 s22, 8388608
    s_mov_b32 s23, 0x00020000
    v_lshrrev_b32 v16, 4, v0
    v_and_b32 v17, 15, v0
    v_lshlrev_b32 v18, 11, v16
    v_lshl_add_u32 v18, v17, 3, v18
    s_lshl_b32 s29, s30, 18
    s_lshl_b32 s37, s28, 16
    s_add_u32 s29, s29, s37
    s_lshl_b32 s37, s31, 7
    s_add_u32 s29, s29, s37
    v_lshlrev_b32 v19, 3, v17
    v_add_u32 v19, s37, v19
    global_load_dwordx2 v[20:21], v19, s[24:25]

    buffer_load_dwordx2 v[128:129], v18, s[16:19], s29 offen
    s_add_u32 s29, s29, 8192
    buffer_load_dwordx2 v[130:131], v18, s[16:19], s29 offen
    s_add_u32 s29, s29, 8192
    buffer_load_dwordx2 v[132:133], v18, s[16:19], s29 offen
    s_add_u32 s29, s29, 8192
    buffer_load_dwordx2 v[134:135], v18, s[16:19], s29 offen
    s_add_u32 s29, s29, 8192
    buffer_load_dwordx2 v[136:137], v18, s[16:19], s29 offen
    s_add_u32 s29, s29, 8192
    buffer_load_dwordx2 v[138:139], v18, s[16:19], s29 offen
    s_add_u32 s29, s29, 8192
    buffer_load_dwordx2 v[140:141], v18, s[16:19], s29 offen
    s_add_u32 s29, s29, 8192
    buffer_load_dwordx2 v[142:143], v18, s[16:19], s29 offen
    v_mov_b32 v64, 0
    v_mov_b32 v65, 0
    v_mov_b32 v66, 0
    v_mov_b32 v67, 0
    v_mov_b32 v68, 0
    v_mov_b32 v69, 0
    v_mov_b32 v70, 0
    v_mov_b32 v71, 0
    v_mov_b32 v72, 0
    v_mov_b32 v73, 0
    v_mov_b32 v74, 0
    v_mov_b32 v75, 0
    v_mov_b32 v76, 0
    v_mov_b32 v77, 0
    v_mov_b32 v78, 0
    v_mov_b32 v79, 0
    v_mov_b32 v80, 0
    v_mov_b32 v81, 0
    v_mov_b32 v82, 0
    v_mov_b32 v83, 0
    v_mov_b32 v84, 0
    v_mov_b32 v85, 0
    v_mov_b32 v86, 0
    v_mov_b32 v87, 0
    v_mov_b32 v88, 0
    v_mov_b32 v89, 0
    v_mov_b32 v90, 0
    v_mov_b32 v91, 0
    v_mov_b32 v92, 0
    v_mov_b32 v93, 0
    v_mov_b32 v94, 0
    v_mov_b32 v95, 0
    v_mov_b32 v96, 0
    v_mov_b32 v97, 0
    v_mov_b32 v98, 0
    v_mov_b32 v99, 0
    v_mov_b32 v100, 0
    v_mov_b32 v101, 0
    v_mov_b32 v102, 0
    v_mov_b32 v103, 0
    v_mov_b32 v104, 0
    v_mov_b32 v105, 0
    v_mov_b32 v106, 0
    v_mov_b32 v107, 0
    v_mov_b32 v108, 0
    v_mov_b32 v109, 0
    v_mov_b32 v110, 0
    v_mov_b32 v111, 0
    v_mov_b32 v112, 0
    v_mov_b32 v113, 0
    v_mov_b32 v114, 0
    v_mov_b32 v115, 0
    v_mov_b32 v116, 0
    v_mov_b32 v117, 0
    v_mov_b32 v118, 0
    v_mov_b32 v119, 0
    v_mov_b32 v120, 0
    v_mov_b32 v121, 0
    v_mov_b32 v122, 0
    v_mov_b32 v123, 0
    v_mov_b32 v124, 0
    v_mov_b32 v125, 0
    v_mov_b32 v126, 0
    v_mov_b32 v127, 0
    s_mov_b32 s35, 5
K2_LOOP:
    s_barrier
    ds_read_b128 v[32:35], v144 offset:0
    ds_read_b128 v[48:51], v148 offset:0
    ds_read_b128 v[36:39], v144 offset:2048
    ds_read_b128 v[52:55], v148 offset:2048
    ds_read_b128 v[40:43], v144 offset:4096
    ds_read_b128 v[56:59], v148 offset:4096
    ds_read_b128 v[44:47], v144 offset:6144
    ds_read_b128 v[60:63], v148 offset:6144
    ds_read_b128 v[168:171], v145 offset:0
    ds_read_b128 v[184:187], v149 offset:0
    ds_read_b128 v[172:175], v145 offset:2048
    ds_read_b128 v[188:191], v149 offset:2048
    ds_read_b128 v[176:179], v145 offset:4096
    ds_read_b128 v[192:195], v149 offset:4096
    ds_read_b128 v[180:183], v145 offset:6144
    ds_read_b128 v[196:199], v149 offset:6144
    s_waitcnt lgkmcnt(8)
    v_mfma_f32_16x16x32_bf16 v[64:67], v[32:35], v[48:51], v[64:67]
    v_mfma_f32_16x16x32_bf16 v[68:71], v[32:35], v[52:55], v[68:71]
    v_mfma_f32_16x16x32_bf16 v[72:75], v[32:35], v[56:59], v[72:75]
    v_mfma_f32_16x16x32_bf16 v[76:79], v[32:35], v[60:63], v[76:79]
    v_mfma_f32_16x16x32_bf16 v[80:83], v[36:39], v[48:51], v[80:83]
    v_mfma_f32_16x16x32_bf16 v[84:87], v[36:39], v[52:55], v[84:87]
    v_mfma_f32_16x16x32_bf16 v[88:91], v[36:39], v[56:59], v[88:91]
    v_mfma_f32_16x16x32_bf16 v[92:95], v[36:39], v[60:63], v[92:95]
    v_mfma_f32_16x16x32_bf16 v[96:99], v[40:43], v[48:51], v[96:99]
    v_mfma_f32_16x16x32_bf16 v[100:103], v[40:43], v[52:55], v[100:103]
    v_mfma_f32_16x16x32_bf16 v[104:107], v[40:43], v[56:59], v[104:107]
    v_mfma_f32_16x16x32_bf16 v[108:111], v[40:43], v[60:63], v[108:111]
    v_mfma_f32_16x16x32_bf16 v[112:115], v[44:47], v[48:51], v[112:115]
    v_mfma_f32_16x16x32_bf16 v[116:119], v[44:47], v[52:55], v[116:119]
    v_mfma_f32_16x16x32_bf16 v[120:123], v[44:47], v[56:59], v[120:123]
    v_mfma_f32_16x16x32_bf16 v[124:127], v[44:47], v[60:63], v[124:127]
    s_waitcnt lgkmcnt(0)
    v_mfma_f32_16x16x32_bf16 v[64:67], v[168:171], v[184:187], v[64:67]
    v_mfma_f32_16x16x32_bf16 v[68:71], v[168:171], v[188:191], v[68:71]
    v_mfma_f32_16x16x32_bf16 v[72:75], v[168:171], v[192:195], v[72:75]
    v_mfma_f32_16x16x32_bf16 v[76:79], v[168:171], v[196:199], v[76:79]
    v_mfma_f32_16x16x32_bf16 v[80:83], v[172:175], v[184:187], v[80:83]
    v_mfma_f32_16x16x32_bf16 v[84:87], v[172:175], v[188:191], v[84:87]
    v_mfma_f32_16x16x32_bf16 v[88:91], v[172:175], v[192:195], v[88:91]
    v_mfma_f32_16x16x32_bf16 v[92:95], v[172:175], v[196:199], v[92:95]
    v_mfma_f32_16x16x32_bf16 v[96:99], v[176:179], v[184:187], v[96:99]
    v_mfma_f32_16x16x32_bf16 v[100:103], v[176:179], v[188:191], v[100:103]
    v_mfma_f32_16x16x32_bf16 v[104:107], v[176:179], v[192:195], v[104:107]
    v_mfma_f32_16x16x32_bf16 v[108:111], v[176:179], v[196:199], v[108:111]
    v_mfma_f32_16x16x32_bf16 v[112:115], v[180:183], v[184:187], v[112:115]
    v_mfma_f32_16x16x32_bf16 v[116:119], v[180:183], v[188:191], v[116:119]
    v_mfma_f32_16x16x32_bf16 v[120:123], v[180:183], v[192:195], v[120:123]
    v_mfma_f32_16x16x32_bf16 v[124:127], v[180:183], v[196:199], v[124:127]
    s_barrier
    ds_read_b128 v[32:35], v152 offset:0
    ds_read_b128 v[48:51], v156 offset:0
    ds_read_b128 v[36:39], v152 offset:2048
    ds_read_b128 v[52:55], v156 offset:2048
    ds_read_b128 v[40:43], v152 offset:4096
    ds_read_b128 v[56:59], v156 offset:4096
    ds_read_b128 v[44:47], v152 offset:6144
    ds_read_b128 v[60:63], v156 offset:6144
    ds_read_b128 v[168:171], v153 offset:0
    ds_read_b128 v[184:187], v157 offset:0
    ds_read_b128 v[172:175], v153 offset:2048
    ds_read_b128 v[188:191], v157 offset:2048
    ds_read_b128 v[176:179], v153 offset:4096
    ds_read_b128 v[192:195], v157 offset:4096
    ds_read_b128 v[180:183], v153 offset:6144
    ds_read_b128 v[196:199], v157 offset:6144
    s_waitcnt lgkmcnt(8)
    v_mfma_f32_16x16x32_bf16 v[64:67], v[32:35], v[48:51], v[64:67]
    v_mfma_f32_16x16x32_bf16 v[68:71], v[32:35], v[52:55], v[68:71]
    v_mfma_f32_16x16x32_bf16 v[72:75], v[32:35], v[56:59], v[72:75]
    v_mfma_f32_16x16x32_bf16 v[76:79], v[32:35], v[60:63], v[76:79]
    v_mfma_f32_16x16x32_bf16 v[80:83], v[36:39], v[48:51], v[80:83]
    v_mfma_f32_16x16x32_bf16 v[84:87], v[36:39], v[52:55], v[84:87]
    v_mfma_f32_16x16x32_bf16 v[88:91], v[36:39], v[56:59], v[88:91]
    v_mfma_f32_16x16x32_bf16 v[92:95], v[36:39], v[60:63], v[92:95]
    v_mfma_f32_16x16x32_bf16 v[96:99], v[40:43], v[48:51], v[96:99]
    v_mfma_f32_16x16x32_bf16 v[100:103], v[40:43], v[52:55], v[100:103]
    v_mfma_f32_16x16x32_bf16 v[104:107], v[40:43], v[56:59], v[104:107]
    v_mfma_f32_16x16x32_bf16 v[108:111], v[40:43], v[60:63], v[108:111]
    v_mfma_f32_16x16x32_bf16 v[112:115], v[44:47], v[48:51], v[112:115]
    v_mfma_f32_16x16x32_bf16 v[116:119], v[44:47], v[52:55], v[116:119]
    v_mfma_f32_16x16x32_bf16 v[120:123], v[44:47], v[56:59], v[120:123]
    v_mfma_f32_16x16x32_bf16 v[124:127], v[44:47], v[60:63], v[124:127]
    s_waitcnt lgkmcnt(0)
    v_mfma_f32_16x16x32_bf16 v[64:67], v[168:171], v[184:187], v[64:67]
    v_mfma_f32_16x16x32_bf16 v[68:71], v[168:171], v[188:191], v[68:71]
    v_mfma_f32_16x16x32_bf16 v[72:75], v[168:171], v[192:195], v[72:75]
    v_mfma_f32_16x16x32_bf16 v[76:79], v[168:171], v[196:199], v[76:79]
    v_mfma_f32_16x16x32_bf16 v[80:83], v[172:175], v[184:187], v[80:83]
    v_mfma_f32_16x16x32_bf16 v[84:87], v[172:175], v[188:191], v[84:87]
    v_mfma_f32_16x16x32_bf16 v[88:91], v[172:175], v[192:195], v[88:91]
    v_mfma_f32_16x16x32_bf16 v[92:95], v[172:175], v[196:199], v[92:95]
    v_mfma_f32_16x16x32_bf16 v[96:99], v[176:179], v[184:187], v[96:99]
    v_mfma_f32_16x16x32_bf16 v[100:103], v[176:179], v[188:191], v[100:103]
    v_mfma_f32_16x16x32_bf16 v[104:107], v[176:179], v[192:195], v[104:107]
    v_mfma_f32_16x16x32_bf16 v[108:111], v[176:179], v[196:199], v[108:111]
    v_mfma_f32_16x16x32_bf16 v[112:115], v[180:183], v[184:187], v[112:115]
    v_mfma_f32_16x16x32_bf16 v[116:119], v[180:183], v[188:191], v[116:119]
    v_mfma_f32_16x16x32_bf16 v[120:123], v[180:183], v[192:195], v[120:123]
    v_mfma_f32_16x16x32_bf16 v[124:127], v[180:183], v[196:199], v[124:127]
    s_barrier
    ds_read_b128 v[32:35], v160 offset:0
    ds_read_b128 v[48:51], v164 offset:0
    ds_read_b128 v[36:39], v160 offset:2048
    ds_read_b128 v[52:55], v164 offset:2048
    ds_read_b128 v[40:43], v160 offset:4096
    ds_read_b128 v[56:59], v164 offset:4096
    ds_read_b128 v[44:47], v160 offset:6144
    ds_read_b128 v[60:63], v164 offset:6144
    ds_read_b128 v[168:171], v161 offset:0
    ds_read_b128 v[184:187], v165 offset:0
    ds_read_b128 v[172:175], v161 offset:2048
    ds_read_b128 v[188:191], v165 offset:2048
    ds_read_b128 v[176:179], v161 offset:4096
    ds_read_b128 v[192:195], v165 offset:4096
    ds_read_b128 v[180:183], v161 offset:6144
    ds_read_b128 v[196:199], v165 offset:6144
    s_waitcnt lgkmcnt(8)
    v_mfma_f32_16x16x32_bf16 v[64:67], v[32:35], v[48:51], v[64:67]
    v_mfma_f32_16x16x32_bf16 v[68:71], v[32:35], v[52:55], v[68:71]
    v_mfma_f32_16x16x32_bf16 v[72:75], v[32:35], v[56:59], v[72:75]
    v_mfma_f32_16x16x32_bf16 v[76:79], v[32:35], v[60:63], v[76:79]
    v_mfma_f32_16x16x32_bf16 v[80:83], v[36:39], v[48:51], v[80:83]
    v_mfma_f32_16x16x32_bf16 v[84:87], v[36:39], v[52:55], v[84:87]
    v_mfma_f32_16x16x32_bf16 v[88:91], v[36:39], v[56:59], v[88:91]
    v_mfma_f32_16x16x32_bf16 v[92:95], v[36:39], v[60:63], v[92:95]
    v_mfma_f32_16x16x32_bf16 v[96:99], v[40:43], v[48:51], v[96:99]
    v_mfma_f32_16x16x32_bf16 v[100:103], v[40:43], v[52:55], v[100:103]
    v_mfma_f32_16x16x32_bf16 v[104:107], v[40:43], v[56:59], v[104:107]
    v_mfma_f32_16x16x32_bf16 v[108:111], v[40:43], v[60:63], v[108:111]
    v_mfma_f32_16x16x32_bf16 v[112:115], v[44:47], v[48:51], v[112:115]
    v_mfma_f32_16x16x32_bf16 v[116:119], v[44:47], v[52:55], v[116:119]
    v_mfma_f32_16x16x32_bf16 v[120:123], v[44:47], v[56:59], v[120:123]
    v_mfma_f32_16x16x32_bf16 v[124:127], v[44:47], v[60:63], v[124:127]
    s_waitcnt lgkmcnt(0)
    v_mfma_f32_16x16x32_bf16 v[64:67], v[168:171], v[184:187], v[64:67]
    v_mfma_f32_16x16x32_bf16 v[68:71], v[168:171], v[188:191], v[68:71]
    v_mfma_f32_16x16x32_bf16 v[72:75], v[168:171], v[192:195], v[72:75]
    v_mfma_f32_16x16x32_bf16 v[76:79], v[168:171], v[196:199], v[76:79]
    v_mfma_f32_16x16x32_bf16 v[80:83], v[172:175], v[184:187], v[80:83]
    v_mfma_f32_16x16x32_bf16 v[84:87], v[172:175], v[188:191], v[84:87]
    v_mfma_f32_16x16x32_bf16 v[88:91], v[172:175], v[192:195], v[88:91]
    v_mfma_f32_16x16x32_bf16 v[92:95], v[172:175], v[196:199], v[92:95]
    v_mfma_f32_16x16x32_bf16 v[96:99], v[176:179], v[184:187], v[96:99]
    v_mfma_f32_16x16x32_bf16 v[100:103], v[176:179], v[188:191], v[100:103]
    v_mfma_f32_16x16x32_bf16 v[104:107], v[176:179], v[192:195], v[104:107]
    v_mfma_f32_16x16x32_bf16 v[108:111], v[176:179], v[196:199], v[108:111]
    v_mfma_f32_16x16x32_bf16 v[112:115], v[180:183], v[184:187], v[112:115]
    v_mfma_f32_16x16x32_bf16 v[116:119], v[180:183], v[188:191], v[116:119]
    v_mfma_f32_16x16x32_bf16 v[120:123], v[180:183], v[192:195], v[120:123]
    v_mfma_f32_16x16x32_bf16 v[124:127], v[180:183], v[196:199], v[124:127]
    s_sub_u32 s35, s35, 1
    s_cmp_lg_u32 s35, 0
    s_cbranch_scc1 K2_LOOP

    s_barrier
    ds_read_b128 v[32:35], v144 offset:0
    ds_read_b128 v[48:51], v148 offset:0
    ds_read_b128 v[36:39], v144 offset:2048
    ds_read_b128 v[52:55], v148 offset:2048
    ds_read_b128 v[40:43], v144 offset:4096
    ds_read_b128 v[56:59], v148 offset:4096
    ds_read_b128 v[44:47], v144 offset:6144
    ds_read_b128 v[60:63], v148 offset:6144
    ds_read_b128 v[168:171], v145 offset:0
    ds_read_b128 v[184:187], v149 offset:0
    ds_read_b128 v[172:175], v145 offset:2048
    ds_read_b128 v[188:191], v149 offset:2048
    ds_read_b128 v[176:179], v145 offset:4096
    ds_read_b128 v[192:195], v149 offset:4096
    ds_read_b128 v[180:183], v145 offset:6144
    ds_read_b128 v[196:199], v149 offset:6144
    s_waitcnt lgkmcnt(8)
    v_mfma_f32_16x16x32_bf16 v[64:67], v[32:35], v[48:51], v[64:67]
    v_mfma_f32_16x16x32_bf16 v[68:71], v[32:35], v[52:55], v[68:71]
    v_mfma_f32_16x16x32_bf16 v[72:75], v[32:35], v[56:59], v[72:75]
    v_mfma_f32_16x16x32_bf16 v[76:79], v[32:35], v[60:63], v[76:79]
    v_mfma_f32_16x16x32_bf16 v[80:83], v[36:39], v[48:51], v[80:83]
    v_mfma_f32_16x16x32_bf16 v[84:87], v[36:39], v[52:55], v[84:87]
    v_mfma_f32_16x16x32_bf16 v[88:91], v[36:39], v[56:59], v[88:91]
    v_mfma_f32_16x16x32_bf16 v[92:95], v[36:39], v[60:63], v[92:95]
    v_mfma_f32_16x16x32_bf16 v[96:99], v[40:43], v[48:51], v[96:99]
    v_mfma_f32_16x16x32_bf16 v[100:103], v[40:43], v[52:55], v[100:103]
    v_mfma_f32_16x16x32_bf16 v[104:107], v[40:43], v[56:59], v[104:107]
    v_mfma_f32_16x16x32_bf16 v[108:111], v[40:43], v[60:63], v[108:111]
    v_mfma_f32_16x16x32_bf16 v[112:115], v[44:47], v[48:51], v[112:115]
    v_mfma_f32_16x16x32_bf16 v[116:119], v[44:47], v[52:55], v[116:119]
    v_mfma_f32_16x16x32_bf16 v[120:123], v[44:47], v[56:59], v[120:123]
    v_mfma_f32_16x16x32_bf16 v[124:127], v[44:47], v[60:63], v[124:127]
    s_waitcnt lgkmcnt(0)
    v_mfma_f32_16x16x32_bf16 v[64:67], v[168:171], v[184:187], v[64:67]
    v_mfma_f32_16x16x32_bf16 v[68:71], v[168:171], v[188:191], v[68:71]
    v_mfma_f32_16x16x32_bf16 v[72:75], v[168:171], v[192:195], v[72:75]
    v_mfma_f32_16x16x32_bf16 v[76:79], v[168:171], v[196:199], v[76:79]
    v_mfma_f32_16x16x32_bf16 v[80:83], v[172:175], v[184:187], v[80:83]
    v_mfma_f32_16x16x32_bf16 v[84:87], v[172:175], v[188:191], v[84:87]
    v_mfma_f32_16x16x32_bf16 v[88:91], v[172:175], v[192:195], v[88:91]
    v_mfma_f32_16x16x32_bf16 v[92:95], v[172:175], v[196:199], v[92:95]
    v_mfma_f32_16x16x32_bf16 v[96:99], v[176:179], v[184:187], v[96:99]
    v_mfma_f32_16x16x32_bf16 v[100:103], v[176:179], v[188:191], v[100:103]
    v_mfma_f32_16x16x32_bf16 v[104:107], v[176:179], v[192:195], v[104:107]
    v_mfma_f32_16x16x32_bf16 v[108:111], v[176:179], v[196:199], v[108:111]
    v_mfma_f32_16x16x32_bf16 v[112:115], v[180:183], v[184:187], v[112:115]
    v_mfma_f32_16x16x32_bf16 v[116:119], v[180:183], v[188:191], v[116:119]
    v_mfma_f32_16x16x32_bf16 v[120:123], v[180:183], v[192:195], v[120:123]
    v_mfma_f32_16x16x32_bf16 v[124:127], v[180:183], v[196:199], v[124:127]
    s_nop 15
    s_nop 3
    s_barrier
    s_lshl_b32 s29, s27, 15
    s_lshl_b32 s37, s26, 14
    s_add_u32 s29, s29, s37
    v_lshlrev_b32 v1, 10, v15
    v_lshl_add_u32 v1, v14, 2, v1
    v_add_u32 v1, s29, v1

    ds_write_b32 v1, v64 offset:0
    ds_write_b32 v1, v65 offset:256
    ds_write_b32 v1, v66 offset:512
    ds_write_b32 v1, v67 offset:768
    ds_write_b32 v1, v68 offset:64
    ds_write_b32 v1, v69 offset:320
    ds_write_b32 v1, v70 offset:576
    ds_write_b32 v1, v71 offset:832
    ds_write_b32 v1, v72 offset:128
    ds_write_b32 v1, v73 offset:384
    ds_write_b32 v1, v74 offset:640
    ds_write_b32 v1, v75 offset:896
    ds_write_b32 v1, v76 offset:192
    ds_write_b32 v1, v77 offset:448
    ds_write_b32 v1, v78 offset:704
    ds_write_b32 v1, v79 offset:960
    ds_write_b32 v1, v80 offset:4096
    ds_write_b32 v1, v81 offset:4352
    ds_write_b32 v1, v82 offset:4608
    ds_write_b32 v1, v83 offset:4864
    ds_write_b32 v1, v84 offset:4160
    ds_write_b32 v1, v85 offset:4416
    ds_write_b32 v1, v86 offset:4672
    ds_write_b32 v1, v87 offset:4928
    ds_write_b32 v1, v88 offset:4224
    ds_write_b32 v1, v89 offset:4480
    ds_write_b32 v1, v90 offset:4736
    ds_write_b32 v1, v91 offset:4992
    ds_write_b32 v1, v92 offset:4288
    ds_write_b32 v1, v93 offset:4544
    ds_write_b32 v1, v94 offset:4800
    ds_write_b32 v1, v95 offset:5056
    ds_write_b32 v1, v96 offset:8192
    ds_write_b32 v1, v97 offset:8448
    ds_write_b32 v1, v98 offset:8704
    ds_write_b32 v1, v99 offset:8960
    ds_write_b32 v1, v100 offset:8256
    ds_write_b32 v1, v101 offset:8512
    ds_write_b32 v1, v102 offset:8768
    ds_write_b32 v1, v103 offset:9024
    ds_write_b32 v1, v104 offset:8320
    ds_write_b32 v1, v105 offset:8576
    ds_write_b32 v1, v106 offset:8832
    ds_write_b32 v1, v107 offset:9088
    ds_write_b32 v1, v108 offset:8384
    ds_write_b32 v1, v109 offset:8640
    ds_write_b32 v1, v110 offset:8896
    ds_write_b32 v1, v111 offset:9152
    ds_write_b32 v1, v112 offset:12288
    ds_write_b32 v1, v113 offset:12544
    ds_write_b32 v1, v114 offset:12800
    ds_write_b32 v1, v115 offset:13056
    ds_write_b32 v1, v116 offset:12352
    ds_write_b32 v1, v117 offset:12608
    ds_write_b32 v1, v118 offset:12864
    ds_write_b32 v1, v119 offset:13120
    ds_write_b32 v1, v120 offset:12416
    ds_write_b32 v1, v121 offset:12672
    ds_write_b32 v1, v122 offset:12928
    ds_write_b32 v1, v123 offset:13184
    ds_write_b32 v1, v124 offset:12480
    ds_write_b32 v1, v125 offset:12736
    ds_write_b32 v1, v126 offset:12992
    ds_write_b32 v1, v127 offset:13248
    s_lshl_b32 s29, s28, 13
    v_lshlrev_b32 v2, 8, v16
    v_lshl_add_u32 v2, v17, 4, v2
    v_add_u32 v2, s29, v2
    v_lshlrev_b32 v3, 12, v16
    v_lshl_add_u32 v3, v17, 4, v3
    s_lshl_b32 s29, s30, 19
    s_lshl_b32 s37, s28, 17
    s_add_u32 s29, s29, s37
    s_lshl_b32 s37, s31, 8
    s_add_u32 s29, s29, s37
    s_waitcnt vmcnt(0)
    v_lshlrev_b32 v22, 16, v20
    v_and_b32 v23, 0xffff0000, v20
    v_lshlrev_b32 v24, 16, v21
    v_and_b32 v25, 0xffff0000, v21

    v_lshlrev_b32 v32, 16, v128
    v_and_b32 v33, 0xffff0000, v128
    v_lshlrev_b32 v34, 16, v129
    v_and_b32 v35, 0xffff0000, v129
    v_mul_f32 v32, v32, v22
    v_mul_f32 v33, v33, v23
    v_mul_f32 v34, v34, v24
    v_mul_f32 v35, v35, v25
    v_cvt_pk_bf16_f32 v32, v32, v33
    v_cvt_pk_bf16_f32 v34, v34, v35
    v_and_b32 v33, 0xffff0000, v32
    v_lshlrev_b32 v32, 16, v32
    v_and_b32 v35, 0xffff0000, v34
    v_lshlrev_b32 v34, 16, v34

    v_lshlrev_b32 v36, 16, v130
    v_and_b32 v37, 0xffff0000, v130
    v_lshlrev_b32 v38, 16, v131
    v_and_b32 v39, 0xffff0000, v131
    v_mul_f32 v36, v36, v22
    v_mul_f32 v37, v37, v23
    v_mul_f32 v38, v38, v24
    v_mul_f32 v39, v39, v25
    v_cvt_pk_bf16_f32 v36, v36, v37
    v_cvt_pk_bf16_f32 v38, v38, v39
    v_and_b32 v37, 0xffff0000, v36
    v_lshlrev_b32 v36, 16, v36
    v_and_b32 v39, 0xffff0000, v38
    v_lshlrev_b32 v38, 16, v38

    v_lshlrev_b32 v40, 16, v132
    v_and_b32 v41, 0xffff0000, v132
    v_lshlrev_b32 v42, 16, v133
    v_and_b32 v43, 0xffff0000, v133
    v_mul_f32 v40, v40, v22
    v_mul_f32 v41, v41, v23
    v_mul_f32 v42, v42, v24
    v_mul_f32 v43, v43, v25
    v_cvt_pk_bf16_f32 v40, v40, v41
    v_cvt_pk_bf16_f32 v42, v42, v43
    v_and_b32 v41, 0xffff0000, v40
    v_lshlrev_b32 v40, 16, v40
    v_and_b32 v43, 0xffff0000, v42
    v_lshlrev_b32 v42, 16, v42

    v_lshlrev_b32 v44, 16, v134
    v_and_b32 v45, 0xffff0000, v134
    v_lshlrev_b32 v46, 16, v135
    v_and_b32 v47, 0xffff0000, v135
    v_mul_f32 v44, v44, v22
    v_mul_f32 v45, v45, v23
    v_mul_f32 v46, v46, v24
    v_mul_f32 v47, v47, v25
    v_cvt_pk_bf16_f32 v44, v44, v45
    v_cvt_pk_bf16_f32 v46, v46, v47
    v_and_b32 v45, 0xffff0000, v44
    v_lshlrev_b32 v44, 16, v44
    v_and_b32 v47, 0xffff0000, v46
    v_lshlrev_b32 v46, 16, v46

    v_lshlrev_b32 v48, 16, v136
    v_and_b32 v49, 0xffff0000, v136
    v_lshlrev_b32 v50, 16, v137
    v_and_b32 v51, 0xffff0000, v137
    v_mul_f32 v48, v48, v22
    v_mul_f32 v49, v49, v23
    v_mul_f32 v50, v50, v24
    v_mul_f32 v51, v51, v25
    v_cvt_pk_bf16_f32 v48, v48, v49
    v_cvt_pk_bf16_f32 v50, v50, v51
    v_and_b32 v49, 0xffff0000, v48
    v_lshlrev_b32 v48, 16, v48
    v_and_b32 v51, 0xffff0000, v50
    v_lshlrev_b32 v50, 16, v50

    v_lshlrev_b32 v52, 16, v138
    v_and_b32 v53, 0xffff0000, v138
    v_lshlrev_b32 v54, 16, v139
    v_and_b32 v55, 0xffff0000, v139
    v_mul_f32 v52, v52, v22
    v_mul_f32 v53, v53, v23
    v_mul_f32 v54, v54, v24
    v_mul_f32 v55, v55, v25
    v_cvt_pk_bf16_f32 v52, v52, v53
    v_cvt_pk_bf16_f32 v54, v54, v55
    v_and_b32 v53, 0xffff0000, v52
    v_lshlrev_b32 v52, 16, v52
    v_and_b32 v55, 0xffff0000, v54
    v_lshlrev_b32 v54, 16, v54

    v_lshlrev_b32 v56, 16, v140
    v_and_b32 v57, 0xffff0000, v140
    v_lshlrev_b32 v58, 16, v141
    v_and_b32 v59, 0xffff0000, v141
    v_mul_f32 v56, v56, v22
    v_mul_f32 v57, v57, v23
    v_mul_f32 v58, v58, v24
    v_mul_f32 v59, v59, v25
    v_cvt_pk_bf16_f32 v56, v56, v57
    v_cvt_pk_bf16_f32 v58, v58, v59
    v_and_b32 v57, 0xffff0000, v56
    v_lshlrev_b32 v56, 16, v56
    v_and_b32 v59, 0xffff0000, v58
    v_lshlrev_b32 v58, 16, v58

    v_lshlrev_b32 v60, 16, v142
    v_and_b32 v61, 0xffff0000, v142
    v_lshlrev_b32 v62, 16, v143
    v_and_b32 v63, 0xffff0000, v143
    v_mul_f32 v60, v60, v22
    v_mul_f32 v61, v61, v23
    v_mul_f32 v62, v62, v24
    v_mul_f32 v63, v63, v25
    v_cvt_pk_bf16_f32 v60, v60, v61
    v_cvt_pk_bf16_f32 v62, v62, v63
    v_and_b32 v61, 0xffff0000, v60
    v_lshlrev_b32 v60, 16, v60
    v_and_b32 v63, 0xffff0000, v62
    v_lshlrev_b32 v62, 16, v62

    s_waitcnt lgkmcnt(0)
    s_barrier

    ds_read_b128 v[64:67], v2 offset:0
    ds_read_b128 v[68:71], v2 offset:32768
    ds_read_b128 v[72:75], v2 offset:1024
    ds_read_b128 v[76:79], v2 offset:33792
    ds_read_b128 v[80:83], v2 offset:2048
    ds_read_b128 v[84:87], v2 offset:34816
    ds_read_b128 v[88:91], v2 offset:3072
    ds_read_b128 v[92:95], v2 offset:35840
    ds_read_b128 v[96:99], v2 offset:4096
    ds_read_b128 v[100:103], v2 offset:36864
    ds_read_b128 v[104:107], v2 offset:5120
    ds_read_b128 v[108:111], v2 offset:37888
    ds_read_b128 v[112:115], v2 offset:6144
    ds_read_b128 v[116:119], v2 offset:38912
    ds_read_b128 v[120:123], v2 offset:7168
    ds_read_b128 v[124:127], v2 offset:39936
    s_waitcnt lgkmcnt(14)
    v_pk_add_f32 v[64:65], v[64:65], v[68:69]
    v_pk_add_f32 v[66:67], v[66:67], v[70:71]
    v_pk_add_f32 v[64:65], v[64:65], v[32:33]
    v_pk_add_f32 v[66:67], v[66:67], v[34:35]
    buffer_store_dwordx4 v[64:67], v3, s[20:23], s29 offen sc1
    s_add_u32 s29, s29, 16384

    s_waitcnt lgkmcnt(12)
    v_pk_add_f32 v[72:73], v[72:73], v[76:77]
    v_pk_add_f32 v[74:75], v[74:75], v[78:79]
    v_pk_add_f32 v[72:73], v[72:73], v[36:37]
    v_pk_add_f32 v[74:75], v[74:75], v[38:39]
    buffer_store_dwordx4 v[72:75], v3, s[20:23], s29 offen sc1
    s_add_u32 s29, s29, 16384

    s_waitcnt lgkmcnt(10)
    v_pk_add_f32 v[80:81], v[80:81], v[84:85]
    v_pk_add_f32 v[82:83], v[82:83], v[86:87]
    v_pk_add_f32 v[80:81], v[80:81], v[40:41]
    v_pk_add_f32 v[82:83], v[82:83], v[42:43]
    buffer_store_dwordx4 v[80:83], v3, s[20:23], s29 offen sc1
    s_add_u32 s29, s29, 16384

    s_waitcnt lgkmcnt(8)
    v_pk_add_f32 v[88:89], v[88:89], v[92:93]
    v_pk_add_f32 v[90:91], v[90:91], v[94:95]
    v_pk_add_f32 v[88:89], v[88:89], v[44:45]
    v_pk_add_f32 v[90:91], v[90:91], v[46:47]
    buffer_store_dwordx4 v[88:91], v3, s[20:23], s29 offen sc1
    s_add_u32 s29, s29, 16384

    s_waitcnt lgkmcnt(6)
    v_pk_add_f32 v[96:97], v[96:97], v[100:101]
    v_pk_add_f32 v[98:99], v[98:99], v[102:103]
    v_pk_add_f32 v[96:97], v[96:97], v[48:49]
    v_pk_add_f32 v[98:99], v[98:99], v[50:51]
    buffer_store_dwordx4 v[96:99], v3, s[20:23], s29 offen sc1
    s_add_u32 s29, s29, 16384

    s_waitcnt lgkmcnt(4)
    v_pk_add_f32 v[104:105], v[104:105], v[108:109]
    v_pk_add_f32 v[106:107], v[106:107], v[110:111]
    v_pk_add_f32 v[104:105], v[104:105], v[52:53]
    v_pk_add_f32 v[106:107], v[106:107], v[54:55]
    buffer_store_dwordx4 v[104:107], v3, s[20:23], s29 offen sc1
    s_add_u32 s29, s29, 16384

    s_waitcnt lgkmcnt(2)
    v_pk_add_f32 v[112:113], v[112:113], v[116:117]
    v_pk_add_f32 v[114:115], v[114:115], v[118:119]
    v_pk_add_f32 v[112:113], v[112:113], v[56:57]
    v_pk_add_f32 v[114:115], v[114:115], v[58:59]
    buffer_store_dwordx4 v[112:115], v3, s[20:23], s29 offen sc1
    s_add_u32 s29, s29, 16384

    s_waitcnt lgkmcnt(0)
    v_pk_add_f32 v[120:121], v[120:121], v[124:125]
    v_pk_add_f32 v[122:123], v[122:123], v[126:127]
    v_pk_add_f32 v[120:121], v[120:121], v[60:61]
    v_pk_add_f32 v[122:123], v[122:123], v[62:63]
    buffer_store_dwordx4 v[120:123], v3, s[20:23], s29 offen sc1
    s_add_u32 s29, s29, 16384

K2_END:
    s_endpgm
.section .rodata,"a"
.p2align 6

.amdhsa_kernel ssm_k1_kernel
  .amdhsa_next_free_vgpr 256
  .amdhsa_next_free_sgpr 64
  .amdhsa_accum_offset 256
  .amdhsa_group_segment_fixed_size 0
  .amdhsa_kernarg_size 96
  .amdhsa_user_sgpr_count 2
  .amdhsa_user_sgpr_kernarg_segment_ptr 1
  .amdhsa_system_sgpr_workgroup_id_x 1
  .amdhsa_float_denorm_mode_32 3
  .amdhsa_float_denorm_mode_16_64 3
.end_amdhsa_kernel
.p2align 6

.amdhsa_kernel ssm_k2_kernel
  .amdhsa_next_free_vgpr 200
  .amdhsa_next_free_sgpr 64
  .amdhsa_accum_offset 200
  .amdhsa_group_segment_fixed_size 0
  .amdhsa_kernarg_size 96
  .amdhsa_user_sgpr_count 2
  .amdhsa_user_sgpr_kernarg_segment_ptr 1
  .amdhsa_system_sgpr_workgroup_id_x 1
  .amdhsa_float_denorm_mode_32 3
  .amdhsa_float_denorm_mode_16_64 3
.end_amdhsa_kernel
```
